```python
import torch

def _softmax(x, axis=-1):
    return torch.softmax(x, dim=axis)
def _gelu(x):
    return torch.nn.functional.gelu(x, approximate="tanh")
def _silu(x):
    return torch.nn.functional.silu(x)
def _sigmoid(x):
    return torch.sigmoid(x)
def _layernorm(x, axis=-1, eps=1e-5):
    m = x.mean(dim=axis, keepdim=True)
    v = x.var(dim=axis, keepdim=True, unbiased=False)
    return (x - m) / torch.sqrt(v + eps)
def _scatter_add(tgt, idx, src, axis=0):
    return tgt.clone().index_add_(axis, idx, src)
def _segment_sum(src, seg, n):
    out = torch.zeros((n,) + src.shape[1:], dtype=src.dtype)
    return out.index_add_(0, seg, src)
def _pad(x, pw):
    flat = tuple(v for pair in reversed(pw) for v in pair)
    return torch.nn.functional.pad(x, flat)

kernel_name = 'sequential_preLN__sliding_block_cached__glu_gated_bilinear__decode'

def setup_inputs():

    _w = (lambda a: (lambda t: t.to(torch.bfloat16) if t.is_floating_point() else t)(torch.as_tensor(a)))
    def _A_setup():
        B, Sq, D = 2, 1, 448
        Hq, Hkv, Sk, Dh = 16, 8, 32768, 256
        assert Hq % Hkv == 0, (Hq, Hkv)
        return {
            "x": _w((lambda *s: torch.randn(*s, dtype=torch.bfloat16) * 0.05)(B, Sq, D)),
            "k_cache": _w((lambda *s: torch.randn(*s, dtype=torch.bfloat16) * 1.6)(B, Hkv, Sk, Dh)),
            "v_cache": _w((lambda *s: torch.randn(*s, dtype=torch.bfloat16) * 0.8)(B, Hkv, Sk, Dh)),
            "wq": _w((lambda *s: torch.randn(*s, dtype=torch.bfloat16) * 1.6)(D, Hq * Dh) * (D ** -0.5)),
            "wo": _w((lambda *s: torch.randn(*s, dtype=torch.bfloat16) * 0.8)(Hq * Dh, D) * ((Hq * Dh) ** -0.5)),
        }
    _A_in = _A_setup()

    def _B_setup():
        B, S, D, F = 2, 1, 448, 1792
        return {
            "x": _w((lambda *s: torch.randn(*s, dtype=torch.bfloat16) * 0.05)(B, S, D)),
            "w_gate": _w((lambda *s: torch.randn(*s, dtype=torch.bfloat16) * 0.4)(D, F) * (D ** -0.5)),
            "w_up": _w((lambda *s: torch.randn(*s, dtype=torch.bfloat16) * 0.4)(D, F) * (D ** -0.5)),
            "w_down": _w((lambda *s: torch.randn(*s, dtype=torch.bfloat16) * 0.4)(F, D) * (F ** -0.5)),
        }
    _B_in = _B_setup()

    return {
        "A_x": _A_in["x"],
        "A_k_cache": _A_in["k_cache"],
        "A_v_cache": _A_in["v_cache"],
        "A_wq": _A_in["wq"],
        "A_wo": _A_in["wo"],
        "B_x": _B_in["x"],
        "B_w_gate": _B_in["w_gate"],
        "B_w_up": _B_in["w_up"],
        "B_w_down": _B_in["w_down"],
    }

def reference(A_x, A_k_cache, A_v_cache, A_wq, A_wo, B_x, B_w_gate, B_w_up, B_w_down):
    def _A_ref(x, k_cache, v_cache, wq, wo):
        B, Sq, D = x.shape
        Hq, Dh = 16, 256
        Hkv, Sk = k_cache.shape[1], k_cache.shape[2]
        W = min(4096, max(256, Sk // 4))
        rep = Hq // Hkv
        q = (lambda x, *d: x.permute(*d))((x @ wq).reshape(B, Sq, Hq, Dh), 0, 2, 1, 3)
        k = (lambda x, n, axis: torch.repeat_interleave(x, n, dim=axis))(k_cache[:, :, Sk - W:, :], rep, axis=1)
        v = (lambda x, n, axis: torch.repeat_interleave(x, n, dim=axis))(v_cache[:, :, Sk - W:, :], rep, axis=1)
        scores = torch.einsum("bhqd,bhkd->bhqk", q, k) * (Dh ** -0.5)
        p = _softmax(scores, axis=-1)
        o = torch.einsum("bhqk,bhkd->bhqd", p, v)
        return (lambda x, *d: x.permute(*d))(o, 0, 2, 1, 3).reshape(B, Sq, Hq * Dh) @ wo

    def _B_ref(x, w_gate, w_up, w_down):
        g = torch.einsum("bsd,df->bsf", x, w_gate)
        u = torch.einsum("bsd,df->bsf", x, w_up)
        h = g * u
        return torch.einsum("bsf,fd->bsd", h, w_down)

    x = A_x
    h = x + _A_ref(_layernorm(x, axis=-1), A_k_cache, A_v_cache, A_wq, A_wo)
    h2 = h + _B_ref(_layernorm(h, axis=-1), B_w_gate, B_w_up, B_w_down)
    return h2
```

```asm
; @launch grid=(256,1,1) block=(512,1,1) lds=83968
.amdgcn_target "amdgcn-amd-amdhsa--gfx950"
.text
.globl sequential_preLN__sliding_block_cached__glu_gated_bilinear__decode_kernel
.p2align 10
.fill 64, 4, 0xbf810000
.p2align 8
.type sequential_preLN__sliding_block_cached__glu_gated_bilinear__decode_kernel,@function
sequential_preLN__sliding_block_cached__glu_gated_bilinear__decode_kernel:
    s_cmp_ge_u32 s2, 256
    s_cbranch_scc1 L_exit
    s_load_dwordx16 s[4:19], s[0:1], 0
    s_load_dwordx8 s[20:27], s[0:1], 64
    v_lshrrev_b32 v1, 6, v0
    v_and_b32 v0, 63, v0
    v_readfirstlane_b32 s28, v1
    s_and_b32 s29, s2, 7
    s_lshr_b32 s30, s2, 3
    s_lshr_b32 s31, s2, 7
    s_and_b32 s32, s30, 15
    v_and_b32 v2, 15, v0
    v_lshrrev_b32 v3, 4, v0
    v_and_b32 v5, 3, v0
    s_mov_b32 s94, 0xffff0000
    s_cmp_eq_u32 s28, 4
    s_cbranch_scc1 L_qwave
    s_cmp_lt_u32 s28, 4
    s_cbranch_scc1 L_setup
    s_mov_b64 exec, 0
    s_cmp_eq_u32 s28, 6
    s_cbranch_scc1 Lpad3
    s_cmp_eq_u32 s28, 7
    s_cbranch_scc1 Lpad4
    s_branch Lpad2
L_back:
    s_mov_b64 exec, -1
L_setup:
    s_lshl_b32 s34, s31, 3
    s_add_u32 s34, s34, s29
    s_lshl_b32 s34, s34, 9
    s_and_b32 s35, s28, 3
    s_lshl_b32 s38, s35, 4
    s_add_u32 s38, s38, s32
    s_add_u32 s34, s34, s38
    s_lshl_b32 s34, s34, 4
    s_lshl_b32 s38, s35, 2
    s_xor_b32 s38, s38, s32
    s_add_u32 s34, s34, s38
    s_lshl_b32 s34, s34, 11
    s_add_u32 s34, s34, 14680064
    s_movk_i32 s50, 0x800
    s_movk_i32 s51, 0x1800
    s_movk_i32 s52, 0x3800
    s_movk_i32 s53, 0x7800
    v_lshrrev_b32 v4, 2, v2
    v_lshlrev_b32 v4, 9, v4
    v_lshl_add_u32 v4, v3, 6, v4
    v_lshl_add_u32 v4, v5, 4, v4
    v_add_u32 v8, s34, v4
    s_lshl_b32 s38, s29, 2
    s_add_u32 s38, s38, s35
    s_mul_i32 s38, s38, 114688
    s_lshl_b32 s39, s32, 6
    s_add_u32 s38, s38, s39
    v_lshrrev_b32 v4, 2, v0
    v_mul_u32_u24 v4, 896, v4
    v_lshl_add_u32 v4, v5, 4, v4
    v_add_u32 v4, s38, v4
    s_and_b32 s38, s32, 1
    s_lshl_b32 s92, s38, 12
    s_mul_i32 s38, s38, 57344
    v_add_u32 v44, s38, v4
    s_sub_u32 s38, 57344, s38
    v_add_u32 v45, s38, v4
    s_lshl_b32 s38, s35, 13
    s_add_u32 s92, s92, s38
    s_add_u32 s92, s92, 49152
    s_xor_b32 s93, s92, 0x1000
L_sdone:
    s_cmp_lt_u32 s30, 16
    s_cselect_b64 vcc, -1, 0
    s_cmp_ge_u32 s28, 4
    s_waitcnt lgkmcnt(0)
    s_cbranch_scc1 L_vpre
    s_mov_b64 s[54:55], s[6:7]
    s_load_dword s33, s[26:27], 0
L_stream:
    s_cbranch_vccnz L_streamb
    global_load_dwordx4 v[128:131], v8, s[54:55] offset:0 nt
    global_load_dwordx4 v[132:135], v8, s[54:55] offset:256 nt
    v_xor_b32 v8, s50, v8
    global_load_dwordx4 v[136:139], v8, s[54:55] offset:0 nt
    global_load_dwordx4 v[140:143], v8, s[54:55] offset:256 nt
    v_xor_b32 v8, s51, v8
    global_load_dwordx4 v[144:147], v8, s[54:55] offset:0 nt
    s_waitcnt vmcnt(4)
    global_load_dwordx4 v[148:151], v8, s[54:55] offset:256 nt
    v_xor_b32 v8, s50, v8
    s_waitcnt vmcnt(4)
    global_load_dwordx4 v[152:155], v8, s[54:55] offset:0 nt
    s_waitcnt vmcnt(4)
    global_load_dwordx4 v[156:159], v8, s[54:55] offset:256 nt
    v_xor_b32 v8, s52, v8
    s_waitcnt vmcnt(4)
    global_load_dwordx4 v[160:163], v8, s[54:55] offset:0 nt
    s_waitcnt vmcnt(4)
    global_load_dwordx4 v[164:167], v8, s[54:55] offset:256 nt
    v_xor_b32 v8, s50, v8
    s_waitcnt vmcnt(4)
    global_load_dwordx4 v[168:171], v8, s[54:55] offset:0 nt
    s_waitcnt vmcnt(4)
    global_load_dwordx4 v[172:175], v8, s[54:55] offset:256 nt
    v_xor_b32 v8, s51, v8
    s_waitcnt vmcnt(4)
    global_load_dwordx4 v[176:179], v8, s[54:55] offset:0 nt
    s_waitcnt vmcnt(4)
    global_load_dwordx4 v[180:183], v8, s[54:55] offset:256 nt
    v_xor_b32 v8, s50, v8
    s_waitcnt vmcnt(4)
    global_load_dwordx4 v[184:187], v8, s[54:55] offset:0 nt
    s_waitcnt vmcnt(4)
    global_load_dwordx4 v[188:191], v8, s[54:55] offset:256 nt
    v_xor_b32 v8, s53, v8
    s_waitcnt vmcnt(4)
    global_load_dwordx4 v[192:195], v8, s[54:55] offset:0 nt
    s_waitcnt vmcnt(4)
    global_load_dwordx4 v[196:199], v8, s[54:55] offset:256 nt
    v_xor_b32 v8, s50, v8
    s_waitcnt vmcnt(4)
    global_load_dwordx4 v[200:203], v8, s[54:55] offset:0 nt
    s_waitcnt vmcnt(4)
    global_load_dwordx4 v[204:207], v8, s[54:55] offset:256 nt
    v_xor_b32 v8, s51, v8
    s_waitcnt vmcnt(4)
    global_load_dwordx4 v[208:211], v8, s[54:55] offset:0 nt
    s_waitcnt vmcnt(4)
    global_load_dwordx4 v[212:215], v8, s[54:55] offset:256 nt
    v_xor_b32 v8, s50, v8
    s_waitcnt vmcnt(4)
    global_load_dwordx4 v[216:219], v8, s[54:55] offset:0 nt
    s_waitcnt vmcnt(4)
    global_load_dwordx4 v[220:223], v8, s[54:55] offset:256 nt
    v_xor_b32 v8, s52, v8
    s_cbranch_scc1 L_vpost
    s_waitcnt vmcnt(4)
    global_load_dwordx4 v[224:227], v8, s[54:55] offset:0 nt
    s_waitcnt vmcnt(4)
    global_load_dwordx4 v[228:231], v8, s[54:55] offset:256 nt
    v_xor_b32 v8, s50, v8
    s_waitcnt vmcnt(4)
    global_load_dwordx4 v[232:235], v8, s[54:55] offset:0 nt
    s_waitcnt vmcnt(4)
    global_load_dwordx4 v[236:239], v8, s[54:55] offset:256 nt
    v_xor_b32 v8, s51, v8
    s_waitcnt vmcnt(4)
    global_load_dwordx4 v[240:243], v8, s[54:55] offset:0 nt
    s_waitcnt vmcnt(4)
    global_load_dwordx4 v[244:247], v8, s[54:55] offset:256 nt
    v_xor_b32 v8, s50, v8
    s_waitcnt vmcnt(4)
    global_load_dwordx4 v[248:251], v8, s[54:55] offset:0 nt
    s_waitcnt vmcnt(4)
    global_load_dwordx4 v[252:255], v8, s[54:55] offset:256 nt
    s_cbranch_scc0 L_kwave
    s_branch L_vpost
L_exit:
    s_endpgm
.p2align 10
L_qwave:
Lpad1:
    s_cbranch_execz Lpad4
    s_setprio 3
    v_and_b32 v4, 31, v0
    v_cmp_gt_u32 s[36:37], 28, v4
    v_lshrrev_b32 v7, 5, v0
    v_mul_u32_u24 v7, 896, v7
    v_lshl_add_u32 v12, v4, 5, v7
    s_lshr_b32 s41, s30, 2
    s_lshl_b32 s42, s29, 2
    s_and_b32 s38, s30, 3
    s_add_u32 s42, s42, s38
    s_mul_i32 s38, s41, 458752
    s_lshl_b32 s39, s42, 8
    s_add_u32 s38, s38, s39
    v_mul_u32_u24 v6, 114688, v3
    v_lshl_add_u32 v6, v2, 4, v6
    v_add_u32 v112, s38, v6
    s_movk_i32 s38, 0x2000
    v_add_u32 v113, s38, v112
    v_add_u32 v114, s38, v113
    v_add_u32 v115, s38, v114
    v_add_u32 v116, s38, v115
    v_add_u32 v117, s38, v116
    v_add_u32 v118, s38, v117
    v_add_u32 v119, s38, v118
    v_add_u32 v120, s38, v119
    v_add_u32 v121, s38, v120
    v_add_u32 v122, s38, v121
    v_add_u32 v123, s38, v122
    v_add_u32 v124, s38, v123
    v_add_u32 v125, s38, v124
    v_mov_b32 v24, -1
    v_mov_b32 v25, -1
    v_mov_b32 v26, -1
    v_mov_b32 v27, -1
    s_lshl_b32 s43, s29, 5
    s_add_u32 s43, s43, s30
    s_lshl_b32 s38, s43, 10
    s_add_u32 s38, s38, 131072
    v_lshl_add_u32 v13, v0, 4, s38
    s_lshl_b32 s38, s43, 3
    s_add_u32 s38, s38, 393216
    v_mov_b32 v15, s38
    v_min_u32 v14, 1760, v12
    s_waitcnt lgkmcnt(0)
    s_load_dword s33, s[26:27], 0
    global_load_dwordx4 v[16:19], v14, s[4:5]
    global_load_dwordx4 v[20:23], v14, s[4:5] offset:16
    global_load_dwordx4 v[128:131], v112, s[10:11] nt
    global_load_dwordx4 v[132:135], v113, s[10:11] nt
    global_load_dwordx4 v[136:139], v114, s[10:11] nt
    global_load_dwordx4 v[140:143], v115, s[10:11] nt
    global_load_dwordx4 v[144:147], v116, s[10:11] nt
    global_load_dwordx4 v[148:151], v117, s[10:11] nt
    global_load_dwordx4 v[152:155], v118, s[10:11] nt
    global_load_dwordx4 v[156:159], v119, s[10:11] nt
    global_load_dwordx4 v[160:163], v120, s[10:11] nt
    global_load_dwordx4 v[164:167], v121, s[10:11] nt
    global_load_dwordx4 v[168:171], v122, s[10:11] nt
    global_load_dwordx4 v[172:175], v123, s[10:11] nt
    global_load_dwordx4 v[176:179], v124, s[10:11] nt
    global_load_dwordx4 v[180:183], v125, s[10:11] nt
    global_store_dwordx4 v13, v[24:27], s[26:27]
    s_mov_b64 exec, 1
    global_store_dwordx2 v15, v[24:25], s[26:27]
    s_getreg_b32 s39, hwreg(HW_REG_XCC_ID, 0, 4)
    s_lshl_b32 s38, s43, 2
    v_mov_b32 v52, s38
    s_waitcnt lgkmcnt(0)
    s_add_u32 s33, s33, 0x9e3779b0
    s_andn2_b32 s33, s33, 15
    s_or_b32 s39, s39, s33
    v_mov_b32 v53, s39
    global_store_dword v52, v53, s[26:27] offset:1024
    s_min_u32 s38, s30, 14
    s_lshl_b32 s38, s38, 3
    s_add_u32 s38, s38, s29
    s_lshl_b32 s38, s38, 7
    s_add_u32 s38, s38, 720896
    s_mov_b64 exec, 0xff
    v_lshl_add_u32 v13, v0, 4, s38
    s_cmp_ge_u32 s30, 14
    s_cbranch_scc1 L_nohclr
    global_store_dwordx4 v13, v[24:27], s[26:27] sc1
L_nohclr:
    s_mov_b64 exec, -1
    s_branch L_qcomp
L_streamb:
    global_load_dwordx4 v[128:131], v8, s[54:55] offset:0 nt
    global_load_dwordx4 v[132:135], v8, s[54:55] offset:256 nt
    v_xor_b32 v8, s50, v8
    global_load_dwordx4 v[136:139], v8, s[54:55] offset:0 nt
    global_load_dwordx4 v[140:143], v8, s[54:55] offset:256 nt
    v_xor_b32 v8, s51, v8
    global_load_dwordx4 v[144:147], v8, s[54:55] offset:0 nt
    global_load_dwordx4 v[148:151], v8, s[54:55] offset:256 nt
    v_xor_b32 v8, s50, v8
    s_waitcnt vmcnt(5)
    global_load_dwordx4 v[152:155], v8, s[54:55] offset:0 nt
    s_waitcnt vmcnt(5)
    global_load_dwordx4 v[156:159], v8, s[54:55] offset:256 nt
    v_xor_b32 v8, s52, v8
    s_waitcnt vmcnt(5)
    global_load_dwordx4 v[160:163], v8, s[54:55] offset:0 nt
    s_waitcnt vmcnt(5)
    global_load_dwordx4 v[164:167], v8, s[54:55] offset:256 nt
    v_xor_b32 v8, s50, v8
    s_waitcnt vmcnt(5)
    global_load_dwordx4 v[168:171], v8, s[54:55] offset:0 nt
    s_waitcnt vmcnt(5)
    global_load_dwordx4 v[172:175], v8, s[54:55] offset:256 nt
    v_xor_b32 v8, s51, v8
    s_waitcnt vmcnt(5)
    global_load_dwordx4 v[176:179], v8, s[54:55] offset:0 nt
    s_waitcnt vmcnt(5)
    global_load_dwordx4 v[180:183], v8, s[54:55] offset:256 nt
    v_xor_b32 v8, s50, v8
    s_waitcnt vmcnt(5)
    global_load_dwordx4 v[184:187], v8, s[54:55] offset:0 nt
    s_waitcnt vmcnt(5)
    global_load_dwordx4 v[188:191], v8, s[54:55] offset:256 nt
    v_xor_b32 v8, s53, v8
    s_waitcnt vmcnt(5)
    global_load_dwordx4 v[192:195], v8, s[54:55] offset:0 nt
    s_waitcnt vmcnt(5)
    global_load_dwordx4 v[196:199], v8, s[54:55] offset:256 nt
    v_xor_b32 v8, s50, v8
    s_waitcnt vmcnt(5)
    global_load_dwordx4 v[200:203], v8, s[54:55] offset:0 nt
    s_waitcnt vmcnt(5)
    global_load_dwordx4 v[204:207], v8, s[54:55] offset:256 nt
    v_xor_b32 v8, s51, v8
    s_waitcnt vmcnt(5)
    global_load_dwordx4 v[208:211], v8, s[54:55] offset:0 nt
    s_waitcnt vmcnt(5)
    global_load_dwordx4 v[212:215], v8, s[54:55] offset:256 nt
    v_xor_b32 v8, s50, v8
    s_waitcnt vmcnt(5)
    global_load_dwordx4 v[216:219], v8, s[54:55] offset:0 nt
    s_waitcnt vmcnt(5)
    global_load_dwordx4 v[220:223], v8, s[54:55] offset:256 nt
    v_xor_b32 v8, s52, v8
    s_cbranch_scc1 L_vpost
    s_waitcnt vmcnt(5)
    global_load_dwordx4 v[224:227], v8, s[54:55] offset:0 nt
    s_waitcnt vmcnt(5)
    global_load_dwordx4 v[228:231], v8, s[54:55] offset:256 nt
    v_xor_b32 v8, s50, v8
    s_waitcnt vmcnt(5)
    global_load_dwordx4 v[232:235], v8, s[54:55] offset:0 nt
    s_waitcnt vmcnt(5)
    global_load_dwordx4 v[236:239], v8, s[54:55] offset:256 nt
    v_xor_b32 v8, s51, v8
    s_waitcnt vmcnt(5)
    global_load_dwordx4 v[240:243], v8, s[54:55] offset:0 nt
    s_waitcnt vmcnt(5)
    global_load_dwordx4 v[244:247], v8, s[54:55] offset:256 nt
    v_xor_b32 v8, s50, v8
    s_waitcnt vmcnt(5)
    global_load_dwordx4 v[248:251], v8, s[54:55] offset:0 nt
    s_waitcnt vmcnt(5)
    global_load_dwordx4 v[252:255], v8, s[54:55] offset:256 nt
    s_cbranch_scc0 L_kwave
    s_branch L_vpost
L_qcomp:
    v_and_b32 v4, 1, v2
    v_lshlrev_b32 v4, 4, v4
    v_mov_b32 v6, 0xffff
    v_lshlrev_b32 v6, v4, v6
    v_bfe_u32 v4, v2, 1, 2
    v_cmp_eq_u32 vcc, 0, v4
    s_nop 1
    v_cndmask_b32 v8, 0, v6, vcc
    v_cmp_eq_u32 vcc, 1, v4
    s_nop 1
    v_cndmask_b32 v9, 0, v6, vcc
    v_cmp_eq_u32 vcc, 2, v4
    s_nop 1
    v_cndmask_b32 v10, 0, v6, vcc
    v_cmp_eq_u32 vcc, 3, v4
    s_nop 1
    v_cndmask_b32 v11, 0, v6, vcc
    s_waitcnt vmcnt(17)
    v_cndmask_b32 v16, 0, v16, s[36:37]
    v_cndmask_b32 v17, 0, v17, s[36:37]
    v_cndmask_b32 v18, 0, v18, s[36:37]
    v_cndmask_b32 v19, 0, v19, s[36:37]
Lpad2:
    s_cbranch_execz Lpad5
    v_cndmask_b32 v20, 0, v20, s[36:37]
    v_cndmask_b32 v21, 0, v21, s[36:37]
    v_cndmask_b32 v22, 0, v22, s[36:37]
    v_cndmask_b32 v23, 0, v23, s[36:37]
    v_lshlrev_b32 v32, 16, v16
    v_and_b32 v33, s94, v16
    v_lshlrev_b32 v34, 16, v17
    v_and_b32 v35, s94, v17
    v_lshlrev_b32 v36, 16, v18
    v_and_b32 v37, s94, v18
    v_lshlrev_b32 v38, 16, v19
    v_and_b32 v39, s94, v19
    v_lshlrev_b32 v40, 16, v20
    v_and_b32 v41, s94, v20
    v_lshlrev_b32 v42, 16, v21
    v_and_b32 v43, s94, v21
    v_lshlrev_b32 v44, 16, v22
    v_and_b32 v45, s94, v22
    v_lshlrev_b32 v46, 16, v23
    v_and_b32 v47, s94, v23
    v_add_f32 v48, v32, v33
    v_add_f32 v48, v48, v34
    v_add_f32 v48, v48, v35
    v_add_f32 v48, v48, v36
    v_add_f32 v48, v48, v37
    v_add_f32 v48, v48, v38
    v_add_f32 v48, v48, v39
    v_add_f32 v48, v48, v40
    v_add_f32 v48, v48, v41
    v_add_f32 v48, v48, v42
    v_add_f32 v48, v48, v43
    v_add_f32 v48, v48, v44
    v_add_f32 v48, v48, v45
    v_add_f32 v48, v48, v46
    v_add_f32 v48, v48, v47
    s_nop 1
    v_add_f32_dpp v48, v48, v48 row_ror:8 row_mask:0xf bank_mask:0xf
    s_nop 1
    v_add_f32_dpp v48, v48, v48 row_ror:4 row_mask:0xf bank_mask:0xf
    s_nop 1
    v_add_f32_dpp v48, v48, v48 row_ror:2 row_mask:0xf bank_mask:0xf
    s_nop 1
    v_add_f32_dpp v48, v48, v48 row_ror:1 row_mask:0xf bank_mask:0xf
    v_mov_b32 v50, v48
    s_nop 1
    v_permlane16_swap_b32 v48, v50
    v_add_f32 v48, v48, v50
    v_mul_f32 v48, 0x3b124925, v48
    v_sub_f32 v50, v32, v48
    v_mul_f32 v49, v50, v50
    v_sub_f32 v50, v33, v48
    v_fmac_f32 v49, v50, v50
    v_sub_f32 v50, v34, v48
    v_fmac_f32 v49, v50, v50
    v_sub_f32 v50, v35, v48
    v_fmac_f32 v49, v50, v50
    v_sub_f32 v50, v36, v48
    v_fmac_f32 v49, v50, v50
    v_sub_f32 v50, v37, v48
    v_fmac_f32 v49, v50, v50
    v_sub_f32 v50, v38, v48
    v_fmac_f32 v49, v50, v50
    v_sub_f32 v50, v39, v48
    v_fmac_f32 v49, v50, v50
    v_sub_f32 v50, v40, v48
    v_fmac_f32 v49, v50, v50
    v_sub_f32 v50, v41, v48
    v_fmac_f32 v49, v50, v50
    v_sub_f32 v50, v42, v48
    v_fmac_f32 v49, v50, v50
    v_sub_f32 v50, v43, v48
    v_fmac_f32 v49, v50, v50
    v_sub_f32 v50, v44, v48
    v_fmac_f32 v49, v50, v50
    v_sub_f32 v50, v45, v48
    v_fmac_f32 v49, v50, v50
    v_sub_f32 v50, v46, v48
    v_fmac_f32 v49, v50, v50
    v_sub_f32 v50, v47, v48
    v_fmac_f32 v49, v50, v50
    v_cndmask_b32 v49, 0, v49, s[36:37]
    s_nop 1
    v_add_f32_dpp v49, v49, v49 row_ror:8 row_mask:0xf bank_mask:0xf
    s_nop 1
    v_add_f32_dpp v49, v49, v49 row_ror:4 row_mask:0xf bank_mask:0xf
    s_nop 1
    v_add_f32_dpp v49, v49, v49 row_ror:2 row_mask:0xf bank_mask:0xf
    s_nop 1
    v_add_f32_dpp v49, v49, v49 row_ror:1 row_mask:0xf bank_mask:0xf
    v_mov_b32 v50, v49
    s_nop 1
    v_permlane16_swap_b32 v49, v50
    v_add_f32 v49, v49, v50
    v_mul_f32 v49, 0x3b124925, v49
    v_cvt_pk_bf16_f32 v49, v49, v49
    v_and_b32 v49, s94, v49
    v_add_f32 v49, 0x3727c5ac, v49
    v_cvt_pk_bf16_f32 v49, v49, v49
    v_and_b32 v49, s94, v49
    v_sqrt_f32 v49, v49
    v_cvt_pk_bf16_f32 v48, v48, v48
    v_and_b32 v48, s94, v48
    v_cvt_pk_bf16_f32 v49, v49, v49
    v_and_b32 v49, s94, v49
    v_rcp_f32 v49, v49
    v_sub_f32 v32, v32, v48
    v_sub_f32 v33, v33, v48
    v_sub_f32 v34, v34, v48
    v_sub_f32 v35, v35, v48
    v_sub_f32 v36, v36, v48
    v_sub_f32 v37, v37, v48
    v_sub_f32 v38, v38, v48
    v_sub_f32 v39, v39, v48
    v_sub_f32 v40, v40, v48
    v_sub_f32 v41, v41, v48
    v_sub_f32 v42, v42, v48
    v_sub_f32 v43, v43, v48
    v_sub_f32 v44, v44, v48
    v_sub_f32 v45, v45, v48
    v_sub_f32 v46, v46, v48
    v_sub_f32 v47, v47, v48
    v_cvt_pk_bf16_f32 v16, v32, v33
    v_cvt_pk_bf16_f32 v17, v34, v35
    v_cvt_pk_bf16_f32 v18, v36, v37
    v_cvt_pk_bf16_f32 v19, v38, v39
    v_cvt_pk_bf16_f32 v20, v40, v41
    v_cvt_pk_bf16_f32 v21, v42, v43
    v_cvt_pk_bf16_f32 v22, v44, v45
    v_cvt_pk_bf16_f32 v23, v46, v47
    v_lshlrev_b32 v32, 16, v16
    v_and_b32 v33, s94, v16
    v_lshlrev_b32 v34, 16, v17
    v_and_b32 v35, s94, v17
    v_lshlrev_b32 v36, 16, v18
    v_and_b32 v37, s94, v18
    v_lshlrev_b32 v38, 16, v19
    v_and_b32 v39, s94, v19
    v_lshlrev_b32 v40, 16, v20
    v_and_b32 v41, s94, v20
    v_lshlrev_b32 v42, 16, v21
    v_and_b32 v43, s94, v21
    v_lshlrev_b32 v44, 16, v22
    v_and_b32 v45, s94, v22
    v_lshlrev_b32 v46, 16, v23
    v_and_b32 v47, s94, v23
    v_mul_f32 v32, v32, v49
    v_mul_f32 v33, v33, v49
    v_mul_f32 v34, v34, v49
    v_mul_f32 v35, v35, v49
    v_mul_f32 v36, v36, v49
    v_mul_f32 v37, v37, v49
    v_mul_f32 v38, v38, v49
    v_mul_f32 v39, v39, v49
    v_mul_f32 v40, v40, v49
    v_mul_f32 v41, v41, v49
    v_mul_f32 v42, v42, v49
    v_mul_f32 v43, v43, v49
    v_mul_f32 v44, v44, v49
    v_mul_f32 v45, v45, v49
    v_mul_f32 v46, v46, v49
    v_mul_f32 v47, v47, v49
    v_cvt_pk_bf16_f32 v32, v32, v32
    v_cvt_pk_bf16_f32 v33, v33, v33
    v_cvt_pk_bf16_f32 v34, v34, v34
    v_cvt_pk_bf16_f32 v35, v35, v35
    v_cvt_pk_bf16_f32 v36, v36, v36
    v_cvt_pk_bf16_f32 v37, v37, v37
    v_cvt_pk_bf16_f32 v38, v38, v38
    v_cvt_pk_bf16_f32 v39, v39, v39
    v_cvt_pk_bf16_f32 v40, v40, v40
    v_cvt_pk_bf16_f32 v41, v41, v41
    v_cvt_pk_bf16_f32 v42, v42, v42
    v_cvt_pk_bf16_f32 v43, v43, v43
    v_cvt_pk_bf16_f32 v44, v44, v44
    v_cvt_pk_bf16_f32 v45, v45, v45
    v_cvt_pk_bf16_f32 v46, v46, v46
    v_cvt_pk_bf16_f32 v47, v47, v47
    v_lshlrev_b32 v12, 1, v12
    s_mov_b64 exec, s[36:37]
    ds_write_b128 v12, v[32:35] offset:32768
    ds_write_b128 v12, v[36:39] offset:32784
    ds_write_b128 v12, v[40:43] offset:32800
    ds_write_b128 v12, v[44:47] offset:32816
    s_mov_b64 exec, -1
    v_lshrrev_b32 v4, 3, v2
    v_mul_u32_u24 v4, 1792, v4
    v_mul_u32_u24 v7, 56, v3
    s_mul_i32 s38, s41, 224
    v_add3_u32 v7, v7, v4, s38
    s_waitcnt lgkmcnt(0)
    ds_read_b64 v[16:17], v7 offset:32768
    ds_read_b64 v[18:19], v7 offset:32776
    ds_read_b64 v[20:21], v7 offset:32784
    ds_read_b64 v[22:23], v7 offset:32792
    ds_read_b64 v[24:25], v7 offset:32800
    ds_read_b64 v[26:27], v7 offset:32808
    ds_read_b64 v[28:29], v7 offset:32816
Lpad3:
    s_cbranch_execz Lpad6
    s_lshl_b32 s38, s29, 7
    v_and_b32 v6, 31, v0
    v_lshl_add_u32 v54, v6, 2, s38
    global_load_dword v55, v54, s[26:27] offset:1024 sc1
    s_lshl_b32 s38, s29, 15
    s_lshl_b32 s41, s41, 11
    s_add_u32 s38, s38, s41
    s_and_b32 s41, s42, 3
    s_lshl_b32 s41, s41, 9
    s_add_u32 s38, s38, s41
    s_add_u32 s38, s38, 1310720
    v_lshrrev_b32 v4, 5, v0
    v_lshlrev_b32 v4, 14, v4
    v_lshl_add_u32 v4, v6, 4, v4
    v_add_u32 v4, s38, v4
    s_lshr_b32 s41, s33, 4
    v_mov_b32 v37, s41
    v_lshrrev_b32 v38, 7, v37
    v_lshrrev_b32 v39, 14, v37
    v_lshrrev_b32 v40, 21, v37
    s_movk_i32 s41, 0x7f
    s_waitcnt lgkmcnt(0)
    v_and_b32 v192, v16, v8
    v_and_b32 v193, v16, v9
    v_and_b32 v194, v16, v10
    v_and_b32 v195, v16, v11
    v_and_b32 v196, v17, v8
    v_and_b32 v197, v17, v9
    v_and_b32 v198, v17, v10
    v_and_b32 v199, v17, v11
    v_and_b32 v200, v18, v8
    v_and_b32 v201, v18, v9
    v_and_b32 v202, v18, v10
    v_and_b32 v203, v18, v11
    v_and_b32 v204, v19, v8
    v_and_b32 v205, v19, v9
    v_and_b32 v206, v19, v10
    v_and_b32 v207, v19, v11
    v_and_b32 v208, v20, v8
    v_and_b32 v209, v20, v9
    v_and_b32 v210, v20, v10
    v_and_b32 v211, v20, v11
    v_and_b32 v212, v21, v8
    v_and_b32 v213, v21, v9
    v_and_b32 v214, v21, v10
    v_and_b32 v215, v21, v11
    v_and_b32 v216, v22, v8
    v_and_b32 v217, v22, v9
    v_and_b32 v218, v22, v10
    v_and_b32 v219, v22, v11
    v_and_b32 v220, v23, v8
    v_and_b32 v221, v23, v9
    v_and_b32 v222, v23, v10
    v_and_b32 v223, v23, v11
    v_and_b32 v224, v24, v8
    v_and_b32 v225, v24, v9
    v_and_b32 v226, v24, v10
    v_and_b32 v227, v24, v11
    v_and_b32 v228, v25, v8
    v_and_b32 v229, v25, v9
    v_and_b32 v230, v25, v10
    v_and_b32 v231, v25, v11
    v_and_b32 v232, v26, v8
    v_and_b32 v233, v26, v9
    v_and_b32 v234, v26, v10
    v_and_b32 v235, v26, v11
    v_and_b32 v236, v27, v8
    v_and_b32 v237, v27, v9
    v_and_b32 v238, v27, v10
    v_and_b32 v239, v27, v11
    v_and_b32 v240, v28, v8
    v_and_b32 v241, v28, v9
    v_and_b32 v242, v28, v10
    v_and_b32 v243, v28, v11
    v_and_b32 v244, v29, v8
    v_and_b32 v245, v29, v9
    v_and_b32 v246, v29, v10
    v_and_b32 v247, v29, v11
    s_waitcnt vmcnt(1)
    v_mfma_f32_16x16x32_bf16 v[32:35], v[192:195], v[128:131], 0
    v_mfma_f32_16x16x32_bf16 v[32:35], v[196:199], v[132:135], v[32:35]
    v_mfma_f32_16x16x32_bf16 v[32:35], v[200:203], v[136:139], v[32:35]
    v_mfma_f32_16x16x32_bf16 v[32:35], v[204:207], v[140:143], v[32:35]
    v_mfma_f32_16x16x32_bf16 v[32:35], v[208:211], v[144:147], v[32:35]
    v_mfma_f32_16x16x32_bf16 v[32:35], v[212:215], v[148:151], v[32:35]
    v_mfma_f32_16x16x32_bf16 v[32:35], v[216:219], v[152:155], v[32:35]
    v_mfma_f32_16x16x32_bf16 v[32:35], v[220:223], v[156:159], v[32:35]
    v_mfma_f32_16x16x32_bf16 v[32:35], v[224:227], v[160:163], v[32:35]
    v_mfma_f32_16x16x32_bf16 v[32:35], v[228:231], v[164:167], v[32:35]
    v_mfma_f32_16x16x32_bf16 v[32:35], v[232:235], v[168:171], v[32:35]
    v_mfma_f32_16x16x32_bf16 v[32:35], v[236:239], v[172:175], v[32:35]
    v_mfma_f32_16x16x32_bf16 v[32:35], v[240:243], v[176:179], v[32:35]
    v_mfma_f32_16x16x32_bf16 v[32:35], v[244:247], v[180:183], v[32:35]
    s_mov_b32 s40, 0
    s_waitcnt vmcnt(0)
    v_cmp_ne_u32 vcc, s39, v55
    s_nop 4
    v_add_u32 v32, 64, v32
    v_add_u32 v33, 64, v33
    v_add_u32 v34, 64, v34
    v_add_u32 v35, 64, v35
    v_bfi_b32 v32, s41, v37, v32
    v_bfi_b32 v33, s41, v38, v33
    v_bfi_b32 v34, s41, v39, v34
    v_bfi_b32 v35, s41, v40, v35
    v_mov_b32 v28, 0
    v_mov_b32 v29, 0
    s_cbranch_vccnz L_px
L_qfast:
    global_store_dwordx4 v4, v[32:35], s[26:27]
L_qpub:
    ds_write_b32 v28, v29 offset:1920
    s_setprio 0
    s_branch L_setup
L_px:
    s_sleep 2
    s_add_u32 s40, s40, 1
    s_cmp_lg_u32 s40, 24
    s_cbranch_scc1 L_px1
    s_mov_b64 exec, 1
    global_store_dword v52, v53, s[26:27] offset:2048 sc1
    s_mov_b64 exec, -1
L_px1:
    global_load_dword v55, v54, s[26:27] offset:1024 sc1
    v_mov_b32 v56, 16
    s_cmp_lt_u32 s40, 24
    s_cbranch_scc1 L_px2
    global_load_dword v56, v54, s[26:27] offset:2048 sc1
    s_waitcnt vmcnt(0)
    v_xor_b32 v56, s39, v56
L_px2:
    s_waitcnt vmcnt(0)
    v_xor_b32 v55, s39, v55
    v_min_u32 v55, v55, v56
    v_cmp_ne_u32 vcc, 0, v55
    s_cbranch_vccz L_qfast
    v_add_u32 v55, -1, v55
    v_cmp_gt_u32 vcc, 15, v55
    s_cbranch_vccnz L_qslow
    s_cmp_lt_u32 s40, 131072
    s_cbranch_scc1 L_px
L_qslow:
    global_store_dwordx4 v4, v[32:35], s[26:27] sc1
    s_mov_b64 exec, 1
    global_store_dword v52, v53, s[26:27] offset:2048 sc1
    s_mov_b64 exec, -1
    v_mov_b32 v29, 0x100
    s_branch L_qpub
L_vpre:
    v_lshlrev_b32 v4, 9, v3
    v_lshl_add_u32 v4, v2, 4, v4
    v_add_u32 v8, s34, v4
    s_mov_b64 s[54:55], s[8:9]
    v_and_b32 v4, 1, v2
    v_lshlrev_b32 v4, 4, v4
    v_mov_b32 v6, 0xffff
    v_lshlrev_b32 v6, v4, v6
    v_bfe_u32 v4, v2, 1, 2
    v_cmp_eq_u32 vcc, 0, v4
    s_nop 1
    v_cndmask_b32 v12, 0, v6, vcc
    v_cmp_eq_u32 vcc, 1, v4
    s_nop 1
    v_cndmask_b32 v13, 0, v6, vcc
    v_cmp_eq_u32 vcc, 2, v4
    s_nop 1
    v_cndmask_b32 v14, 0, v6, vcc
    v_cmp_eq_u32 vcc, 3, v4
    s_nop 1
    v_cndmask_b32 v15, 0, v6, vcc
    s_lshl_b32 s38, s35, 12
    v_lshl_add_u32 v4, v0, 4, s38
    s_lshl_b32 s38, s35, 11
    v_lshrrev_b32 v7, 1, v3
    v_lshlrev_b32 v7, 10, v7
    v_lshl_add_u32 v7, v2, 5, v7
    v_and_b32 v6, 1, v3
    v_lshl_add_u32 v7, v6, 4, v7
    v_add_u32 v7, s38, v7
    s_cmp_lt_u32 s30, 16
    s_cselect_b64 vcc, -1, 0
    s_cmp_ge_u32 s28, 4
    s_barrier
    s_branch L_stream
L_vpost:
    s_barrier
    ds_read_b128 v[16:19], v4 offset:8192
    ds_read_b128 v[20:23], v4 offset:9216
    ds_read_b128 v[24:27], v4 offset:10240
    ds_read_b128 v[28:31], v4 offset:11264
    s_waitcnt vmcnt(5)
    global_load_dwordx4 v[224:227], v8, s[54:55] offset:0 nt
    s_waitcnt lgkmcnt(0)
    v_and_b32 v64, v16, v12
    v_and_b32 v65, v16, v13
    v_and_b32 v66, v16, v14
    v_and_b32 v67, v16, v15
    v_and_b32 v68, v17, v12
    v_and_b32 v69, v17, v13
    v_and_b32 v70, v17, v14
    v_and_b32 v71, v17, v15
    v_mfma_f32_16x16x32_bf16 v[32:35], v[64:67], v[128:131], 0
    v_mfma_f32_16x16x32_bf16 v[36:39], v[64:67], v[132:135], 0
    v_and_b32 v72, v18, v12
    v_and_b32 v73, v18, v13
    v_and_b32 v74, v18, v14
    v_and_b32 v75, v18, v15
    v_mfma_f32_16x16x32_bf16 v[32:35], v[68:71], v[136:139], v[32:35]
    v_mfma_f32_16x16x32_bf16 v[36:39], v[68:71], v[140:143], v[36:39]
    v_and_b32 v76, v19, v12
    v_and_b32 v77, v19, v13
    v_and_b32 v78, v19, v14
    v_and_b32 v79, v19, v15
    v_mfma_f32_16x16x32_bf16 v[32:35], v[72:75], v[144:147], v[32:35]
    v_mfma_f32_16x16x32_bf16 v[36:39], v[72:75], v[148:151], v[36:39]
Lpad4:
    s_cbranch_execz Lpad7
    s_waitcnt vmcnt(5)
    global_load_dwordx4 v[228:231], v8, s[54:55] offset:256 nt
    v_xor_b32 v8, s50, v8
    v_and_b32 v80, v20, v12
    v_and_b32 v81, v20, v13
    v_and_b32 v82, v20, v14
    v_and_b32 v83, v20, v15
    v_mfma_f32_16x16x32_bf16 v[32:35], v[76:79], v[152:155], v[32:35]
    v_mfma_f32_16x16x32_bf16 v[36:39], v[76:79], v[156:159], v[36:39]
    v_and_b32 v84, v21, v12
    v_and_b32 v85, v21, v13
    v_and_b32 v86, v21, v14
    v_and_b32 v87, v21, v15
    v_mfma_f32_16x16x32_bf16 v[32:35], v[80:83], v[160:163], v[32:35]
    v_mfma_f32_16x16x32_bf16 v[36:39], v[80:83], v[164:167], v[36:39]
    v_and_b32 v88, v22, v12
    v_and_b32 v89, v22, v13
    v_and_b32 v90, v22, v14
    v_and_b32 v91, v22, v15
    v_mfma_f32_16x16x32_bf16 v[32:35], v[84:87], v[168:171], v[32:35]
    v_mfma_f32_16x16x32_bf16 v[36:39], v[84:87], v[172:175], v[36:39]
    s_waitcnt vmcnt(5)
    global_load_dwordx4 v[232:235], v8, s[54:55] offset:0 nt
    v_and_b32 v92, v23, v12
    v_and_b32 v93, v23, v13
    v_and_b32 v94, v23, v14
    v_and_b32 v95, v23, v15
    v_mfma_f32_16x16x32_bf16 v[32:35], v[88:91], v[176:179], v[32:35]
    v_mfma_f32_16x16x32_bf16 v[36:39], v[88:91], v[180:183], v[36:39]
    v_and_b32 v96, v24, v12
    v_and_b32 v97, v24, v13
    v_and_b32 v98, v24, v14
    v_and_b32 v99, v24, v15
    v_mfma_f32_16x16x32_bf16 v[32:35], v[92:95], v[184:187], v[32:35]
    v_mfma_f32_16x16x32_bf16 v[36:39], v[92:95], v[188:191], v[36:39]
    v_and_b32 v100, v25, v12
    v_and_b32 v101, v25, v13
    v_and_b32 v102, v25, v14
    v_and_b32 v103, v25, v15
    v_mfma_f32_16x16x32_bf16 v[32:35], v[96:99], v[192:195], v[32:35]
    v_mfma_f32_16x16x32_bf16 v[36:39], v[96:99], v[196:199], v[36:39]
    s_waitcnt vmcnt(5)
    global_load_dwordx4 v[236:239], v8, s[54:55] offset:256 nt
    v_xor_b32 v8, s51, v8
    v_and_b32 v104, v26, v12
    v_and_b32 v105, v26, v13
    v_and_b32 v106, v26, v14
    v_and_b32 v107, v26, v15
    v_mfma_f32_16x16x32_bf16 v[32:35], v[100:103], v[200:203], v[32:35]
    v_mfma_f32_16x16x32_bf16 v[36:39], v[100:103], v[204:207], v[36:39]
    v_and_b32 v108, v27, v12
    v_and_b32 v109, v27, v13
    v_and_b32 v110, v27, v14
    v_and_b32 v111, v27, v15
    v_mfma_f32_16x16x32_bf16 v[32:35], v[104:107], v[208:211], v[32:35]
    v_mfma_f32_16x16x32_bf16 v[36:39], v[104:107], v[212:215], v[36:39]
    s_waitcnt vmcnt(5)
    global_load_dwordx4 v[240:243], v8, s[54:55] offset:0 nt
    v_and_b32 v112, v28, v12
    v_and_b32 v113, v28, v13
    v_and_b32 v114, v28, v14
    v_and_b32 v115, v28, v15
    v_mfma_f32_16x16x32_bf16 v[32:35], v[108:111], v[216:219], v[32:35]
    s_waitcnt vmcnt(5)
    global_load_dwordx4 v[244:247], v8, s[54:55] offset:256 nt
    v_xor_b32 v8, s50, v8
    v_mfma_f32_16x16x32_bf16 v[36:39], v[108:111], v[220:223], v[36:39]
    s_waitcnt vmcnt(5)
    global_load_dwordx4 v[248:251], v8, s[54:55] offset:0 nt
    v_and_b32 v116, v29, v12
    v_and_b32 v117, v29, v13
    v_and_b32 v118, v29, v14
    v_and_b32 v119, v29, v15
    v_mfma_f32_16x16x32_bf16 v[32:35], v[112:115], v[224:227], v[32:35]
    s_waitcnt vmcnt(5)
    global_load_dwordx4 v[252:255], v8, s[54:55] offset:256 nt
    s_barrier
    v_mfma_f32_16x16x32_bf16 v[36:39], v[112:115], v[228:231], v[36:39]
    v_and_b32 v120, v30, v12
    v_and_b32 v121, v30, v13
    v_and_b32 v122, v30, v14
    v_and_b32 v123, v30, v15
    v_and_b32 v124, v31, v12
    v_and_b32 v125, v31, v13
    v_and_b32 v126, v31, v14
    v_and_b32 v127, v31, v15
    s_waitcnt vmcnt(5)
    v_mfma_f32_16x16x32_bf16 v[32:35], v[116:119], v[232:235], v[32:35]
    s_waitcnt vmcnt(4)
    v_mfma_f32_16x16x32_bf16 v[36:39], v[116:119], v[236:239], v[36:39]
    s_waitcnt vmcnt(3)
    v_mfma_f32_16x16x32_bf16 v[32:35], v[120:123], v[240:243], v[32:35]
    s_waitcnt vmcnt(2)
    v_mfma_f32_16x16x32_bf16 v[36:39], v[120:123], v[244:247], v[36:39]
    s_waitcnt vmcnt(1)
    v_mfma_f32_16x16x32_bf16 v[32:35], v[124:127], v[248:251], v[32:35]
    s_waitcnt vmcnt(0)
    v_mfma_f32_16x16x32_bf16 v[36:39], v[124:127], v[252:255], v[36:39]
    s_nop 5
    ds_write_b128 v7, v[32:35] offset:24576
    s_nop 0
    ds_write_b128 v7, v[36:39] offset:25088
    s_waitcnt lgkmcnt(0)
    s_barrier
L_end:
    s_endpgm
L_kwave:
    s_lshl_b32 s42, s29, 1
    s_add_u32 s42, s42, s31
    s_lshl_b32 s38, s42, 14
    s_lshl_b32 s41, s28, 9
    s_add_u32 s38, s38, s41
    s_add_u32 s38, s38, 1314816
    v_lshrrev_b32 v7, 5, v0
    v_lshlrev_b32 v12, 13, v7
    v_and_b32 v13, 31, v0
    v_lshl_add_u32 v12, v13, 4, v12
    v_add_u32 v12, s38, v12
    global_load_dwordx4 v[16:19], v12, s[26:27] offset:-4096 sc1
    global_load_dwordx4 v[20:23], v12, s[26:27] offset:-2048 sc1
    global_load_dwordx4 v[24:27], v12, s[26:27] offset:0 sc1
    global_load_dwordx4 v[28:31], v12, s[26:27] offset:2048 sc1
    s_barrier
    s_lshl_b32 s45, s29, 4
    s_add_u32 s45, s45, s32
    s_lshl_b32 s44, s29, 1
    s_add_u32 s44, s44, s32
    s_cmp_eq_u32 s29, 7
    s_cbranch_scc1 L_r7
    s_sub_u32 s44, s44, 14
    s_sub_u32 s95, 2, s31
    s_branch L_rd
L_r7:
    s_cmp_lt_u32 s32, 14
    s_cselect_b32 s95, 2, 3
L_rd:
    s_cmp_lt_u32 s30, 14
    s_cselect_b32 s95, 0, s95
    v_lshrrev_b32 v4, 3, v2
    v_lshlrev_b32 v6, 9, v4
    v_lshl_add_u32 v6, v3, 6, v6
    v_lshl_add_u32 v6, v5, 4, v6
    v_mov_b32 v14, 0
    v_and_b32 v10, 1, v3
    v_mul_u32_u24 v10, 896, v10
    v_lshl_add_u32 v10, v2, 2, v10
    s_min_u32 s38, s32, 13
    s_lshl_b32 s38, s38, 6
    v_add_u32 v10, s38, v10
    s_cmp_ge_u32 s95, 2
    s_cselect_b64 s[54:55], s[22:23], s[4:5]
    s_mul_i32 s38, s45, 14336
    s_lshl_b32 s39, s28, 8
    s_add_u32 s38, s38, s39
    v_mul_u32_u24 v43, 3584, v3
    v_lshl_add_u32 v43, v2, 4, v43
    v_add_u32 v43, s38, v43
    s_cmp_eq_u32 s28, 3
    s_cselect_b32 s46, 0x00ff00ff, -1
    v_mov_b32 v46, 0
    v_mov_b32 v47, 0
    s_cmp_lt_u32 s30, 14
    s_cbranch_scc1 L_nofa
    s_lshl_b32 s38, s45, 5
    s_mul_i32 s39, s28, 401408
    s_add_u32 s38, s38, s39
    v_lshrrev_b32 v9, 1, v0
    v_mul_u32_u24 v9, 3584, v9
    v_and_b32 v8, 1, v0
    v_lshl_add_u32 v9, v8, 4, v9
    v_add_u32 v9, s38, v9
    s_and_b32 s41, s45, 3
    s_mul_i32 s39, s28, 3584
    s_xor_b32 s38, s41, 0
    s_cmp_eq_u32 s38, 3
    s_cselect_b32 s88, 0, -1
    s_lshl_b32 s84, s38, 10
    s_add_u32 s84, s84, s39
    s_mul_i32 s38, s38, 114688
    v_add_u32 v44, s38, v9
    s_xor_b32 s38, s41, 1
    s_cmp_eq_u32 s38, 3
    s_cselect_b32 s89, 0, -1
    s_lshl_b32 s85, s38, 10
    s_add_u32 s85, s85, s39
    s_mul_i32 s38, s38, 114688
    v_add_u32 v45, s38, v9
    s_xor_b32 s38, s41, 2
    s_cmp_eq_u32 s38, 3
    s_cselect_b32 s90, 0, -1
    s_lshl_b32 s86, s38, 10
    s_add_u32 s86, s86, s39
    s_mul_i32 s38, s38, 114688
    v_add_u32 v46, s38, v9
    s_xor_b32 s38, s41, 3
    s_cmp_eq_u32 s38, 3
    s_cselect_b32 s91, 0, -1
    s_lshl_b32 s87, s38, 10
    s_add_u32 s87, s87, s39
    s_mul_i32 s38, s38, 114688
    v_add_u32 v47, s38, v9
L_nofa:
Lpad5:
    s_cbranch_execz Lpad8
    s_waitcnt lgkmcnt(0)
    s_add_u32 s33, s33, 0x9e3779b0
    s_andn2_b32 s33, s33, 15
    s_lshr_b32 s56, s33, 4
    s_lshr_b32 s57, s33, 11
    s_lshr_b32 s58, s33, 18
    s_lshr_b32 s59, s33, 25
    s_mov_b32 s40, 131072
    s_branch L_pq_chk
L_pq:
    global_load_dwordx4 v[16:19], v12, s[26:27] offset:-4096 sc1
    global_load_dwordx4 v[20:23], v12, s[26:27] offset:-2048 sc1
    global_load_dwordx4 v[24:27], v12, s[26:27] offset:0 sc1
    global_load_dwordx4 v[28:31], v12, s[26:27] offset:2048 sc1
    s_sub_u32 s40, s40, 1
    s_cbranch_scc1 L_pq_done
L_pq_chk:
    s_waitcnt vmcnt(0)
    v_xor_b32 v38, s56, v16
    v_bitop3_b32 v38, v17, s57, v38 bitop3:0xbe
    v_bitop3_b32 v38, v18, s58, v38 bitop3:0xbe
    v_bitop3_b32 v38, v19, s59, v38 bitop3:0xbe
    v_bitop3_b32 v38, v20, s56, v38 bitop3:0xbe
    v_bitop3_b32 v38, v21, s57, v38 bitop3:0xbe
    v_bitop3_b32 v38, v22, s58, v38 bitop3:0xbe
    v_bitop3_b32 v38, v23, s59, v38 bitop3:0xbe
    v_bitop3_b32 v38, v24, s56, v38 bitop3:0xbe
    v_bitop3_b32 v38, v25, s57, v38 bitop3:0xbe
    v_bitop3_b32 v38, v26, s58, v38 bitop3:0xbe
    v_bitop3_b32 v38, v27, s59, v38 bitop3:0xbe
    v_bitop3_b32 v38, v28, s56, v38 bitop3:0xbe
    v_bitop3_b32 v38, v29, s57, v38 bitop3:0xbe
    v_bitop3_b32 v38, v30, s58, v38 bitop3:0xbe
    v_bitop3_b32 v38, v31, s59, v38 bitop3:0xbe
    v_and_b32 v38, 0x7f, v38
    v_cmp_ne_u32 vcc, 0, v38
    s_and_b64 exec, exec, vcc
    s_cbranch_scc1 L_pq
L_pq_done:
    s_mov_b64 exec, -1
    s_movk_i32 s38, 0xff80
    s_waitcnt vmcnt(0)
    global_load_dword v11, v10, s[54:55]
    v_and_b32 v16, s38, v16
    v_and_b32 v17, s38, v17
    v_and_b32 v18, s38, v18
    v_and_b32 v19, s38, v19
    v_and_b32 v20, s38, v20
    v_and_b32 v21, s38, v21
    v_and_b32 v22, s38, v22
    v_and_b32 v23, s38, v23
    v_and_b32 v24, s38, v24
    v_and_b32 v25, s38, v25
    v_and_b32 v26, s38, v26
    v_and_b32 v27, s38, v27
    v_and_b32 v28, s38, v28
    v_and_b32 v29, s38, v29
    v_and_b32 v30, s38, v30
    v_and_b32 v31, s38, v31
    v_pk_add_f32 v[16:17], v[16:17], v[24:25]
    v_pk_add_f32 v[18:19], v[18:19], v[26:27]
    v_pk_add_f32 v[20:21], v[20:21], v[28:29]
    v_pk_add_f32 v[22:23], v[22:23], v[30:31]
    v_pk_add_f32 v[16:17], v[16:17], v[20:21]
    v_pk_add_f32 v[18:19], v[18:19], v[22:23]
    s_nop 1
    v_permlane32_swap_b32 v16, v18
    v_permlane32_swap_b32 v17, v19
    v_pk_add_f32 v[16:17], v[16:17], v[18:19]
    v_cvt_pk_bf16_f32 v16, v16, v17
    v_lshlrev_b32 v7, 2, v7
    v_lshl_add_u32 v7, v2, 4, v7
    v_and_b32 v13, 1, v3
    v_lshl_add_u32 v7, v13, 3, v7
    s_lshl_b32 s38, s28, 8
    v_add_u32 v7, s38, v7
    v_mov_b32 v13, 1
    ds_write_b32 v7, v16 offset:5120
    s_mov_b64 exec, 1
    ds_add_u32 v14, v13 offset:1920
    s_mov_b64 exec, -1
L_qwait:
    ds_read_b32 v13, v14 offset:1920
    s_sub_u32 s40, s40, 1
    s_cbranch_scc1 L_qgot
    s_waitcnt lgkmcnt(0)
    v_readfirstlane_b32 s48, v13
    s_and_b32 s38, s48, 0xff
    s_cmp_eq_u32 s38, 4
    s_cbranch_scc1 L_qgot
    s_sleep 1
    s_branch L_qwait
L_qgot:
    ds_read_b128 v[32:35], v6 offset:5120
    ds_read_b128 v[36:39], v6 offset:5376
    s_mov_b32 s41, 0x3db8aa3b
    s_cmp_eq_u32 s48, 4
    s_cselect_b32 s49, 0, 294912
    s_lshl_b32 s38, s28, 5
    s_add_u32 s38, s38, s30
    s_cmp_lg_u32 s38, 31
    s_cbranch_scc1 L_nogr
    s_lshl_b32 s38, s29, 7
    s_add_u32 s38, s38, 4096
    v_mov_b32 v12, s38
    v_mov_b32 v13, s33
    s_mov_b64 exec, 1
    global_store_dword v12, v13, s[26:27] sc1
    s_mov_b64 exec, -1
L_nogr:
    s_waitcnt lgkmcnt(0)
    v_mfma_f32_16x16x32_bf16 v[64:67], v[128:131], v[32:35], 0
    v_mfma_f32_16x16x32_bf16 v[64:67], v[132:135], v[36:39], v[64:67]
    v_mfma_f32_16x16x32_bf16 v[68:71], v[136:139], v[32:35], 0
    v_mfma_f32_16x16x32_bf16 v[68:71], v[140:143], v[36:39], v[68:71]
    v_mfma_f32_16x16x32_bf16 v[72:75], v[144:147], v[32:35], 0
    v_mfma_f32_16x16x32_bf16 v[72:75], v[148:151], v[36:39], v[72:75]
    v_mfma_f32_16x16x32_bf16 v[76:79], v[152:155], v[32:35], 0
    v_mfma_f32_16x16x32_bf16 v[76:79], v[156:159], v[36:39], v[76:79]
    v_mfma_f32_16x16x32_bf16 v[80:83], v[160:163], v[32:35], 0
    v_mfma_f32_16x16x32_bf16 v[80:83], v[164:167], v[36:39], v[80:83]
    v_mfma_f32_16x16x32_bf16 v[84:87], v[168:171], v[32:35], 0
    v_mfma_f32_16x16x32_bf16 v[84:87], v[172:175], v[36:39], v[84:87]
    v_mfma_f32_16x16x32_bf16 v[88:91], v[176:179], v[32:35], 0
    v_mfma_f32_16x16x32_bf16 v[88:91], v[180:183], v[36:39], v[88:91]
    v_mfma_f32_16x16x32_bf16 v[92:95], v[184:187], v[32:35], 0
    v_mfma_f32_16x16x32_bf16 v[92:95], v[188:191], v[36:39], v[92:95]
    v_mfma_f32_16x16x32_bf16 v[96:99], v[192:195], v[32:35], 0
    v_mfma_f32_16x16x32_bf16 v[96:99], v[196:199], v[36:39], v[96:99]
    v_mfma_f32_16x16x32_bf16 v[100:103], v[200:203], v[32:35], 0
    v_mfma_f32_16x16x32_bf16 v[100:103], v[204:207], v[36:39], v[100:103]
    v_mfma_f32_16x16x32_bf16 v[104:107], v[208:211], v[32:35], 0
    v_mfma_f32_16x16x32_bf16 v[104:107], v[212:215], v[36:39], v[104:107]
    v_mfma_f32_16x16x32_bf16 v[108:111], v[216:219], v[32:35], 0
    v_mfma_f32_16x16x32_bf16 v[108:111], v[220:223], v[36:39], v[108:111]
    v_mfma_f32_16x16x32_bf16 v[112:115], v[224:227], v[32:35], 0
    v_mfma_f32_16x16x32_bf16 v[112:115], v[228:231], v[36:39], v[112:115]
    v_mfma_f32_16x16x32_bf16 v[116:119], v[232:235], v[32:35], 0
    v_mfma_f32_16x16x32_bf16 v[116:119], v[236:239], v[36:39], v[116:119]
    v_mfma_f32_16x16x32_bf16 v[120:123], v[240:243], v[32:35], 0
    v_mfma_f32_16x16x32_bf16 v[120:123], v[244:247], v[36:39], v[120:123]
    v_mfma_f32_16x16x32_bf16 v[124:127], v[248:251], v[32:35], 0
    v_mfma_f32_16x16x32_bf16 v[124:127], v[252:255], v[36:39], v[124:127]
    v_mov_b32_dpp v16, v64 quad_perm:[0,0,0,0] row_mask:0xf bank_mask:0xf
    v_mov_b32_dpp v17, v68 quad_perm:[0,0,0,0] row_mask:0xf bank_mask:0xf
    v_mov_b32_dpp v18, v72 quad_perm:[0,0,0,0] row_mask:0xf bank_mask:0xf
    v_mov_b32_dpp v19, v76 quad_perm:[0,0,0,0] row_mask:0xf bank_mask:0xf
    v_mov_b32_dpp v20, v80 quad_perm:[0,0,0,0] row_mask:0xf bank_mask:0xf
    v_mov_b32_dpp v21, v84 quad_perm:[0,0,0,0] row_mask:0xf bank_mask:0xf
    v_mov_b32_dpp v22, v88 quad_perm:[0,0,0,0] row_mask:0xf bank_mask:0xf
    v_mov_b32_dpp v23, v92 quad_perm:[0,0,0,0] row_mask:0xf bank_mask:0xf
    v_mov_b32_dpp v24, v96 quad_perm:[0,0,0,0] row_mask:0xf bank_mask:0xf
    v_mov_b32_dpp v25, v100 quad_perm:[0,0,0,0] row_mask:0xf bank_mask:0xf
    v_mov_b32_dpp v26, v104 quad_perm:[0,0,0,0] row_mask:0xf bank_mask:0xf
    v_mov_b32_dpp v27, v108 quad_perm:[0,0,0,0] row_mask:0xf bank_mask:0xf
    v_mov_b32_dpp v28, v112 quad_perm:[0,0,0,0] row_mask:0xf bank_mask:0xf
    v_mov_b32_dpp v29, v116 quad_perm:[0,0,0,0] row_mask:0xf bank_mask:0xf
    v_mov_b32_dpp v30, v120 quad_perm:[0,0,0,0] row_mask:0xf bank_mask:0xf
    v_mov_b32_dpp v31, v124 quad_perm:[0,0,0,0] row_mask:0xf bank_mask:0xf
    v_add_f32_dpp v16, v65, v16 quad_perm:[1,1,1,1] row_mask:0xf bank_mask:0xf
    v_add_f32_dpp v17, v69, v17 quad_perm:[1,1,1,1] row_mask:0xf bank_mask:0xf
    v_add_f32_dpp v18, v73, v18 quad_perm:[1,1,1,1] row_mask:0xf bank_mask:0xf
    v_add_f32_dpp v19, v77, v19 quad_perm:[1,1,1,1] row_mask:0xf bank_mask:0xf
    v_add_f32_dpp v20, v81, v20 quad_perm:[1,1,1,1] row_mask:0xf bank_mask:0xf
    v_add_f32_dpp v21, v85, v21 quad_perm:[1,1,1,1] row_mask:0xf bank_mask:0xf
Lpad6:
    s_cbranch_execz Lpad9
    v_add_f32_dpp v22, v89, v22 quad_perm:[1,1,1,1] row_mask:0xf bank_mask:0xf
    v_add_f32_dpp v23, v93, v23 quad_perm:[1,1,1,1] row_mask:0xf bank_mask:0xf
    v_add_f32_dpp v24, v97, v24 quad_perm:[1,1,1,1] row_mask:0xf bank_mask:0xf
    v_add_f32_dpp v25, v101, v25 quad_perm:[1,1,1,1] row_mask:0xf bank_mask:0xf
    v_add_f32_dpp v26, v105, v26 quad_perm:[1,1,1,1] row_mask:0xf bank_mask:0xf
    v_add_f32_dpp v27, v109, v27 quad_perm:[1,1,1,1] row_mask:0xf bank_mask:0xf
    v_add_f32_dpp v28, v113, v28 quad_perm:[1,1,1,1] row_mask:0xf bank_mask:0xf
    v_add_f32_dpp v29, v117, v29 quad_perm:[1,1,1,1] row_mask:0xf bank_mask:0xf
    v_add_f32_dpp v30, v121, v30 quad_perm:[1,1,1,1] row_mask:0xf bank_mask:0xf
    v_add_f32_dpp v31, v125, v31 quad_perm:[1,1,1,1] row_mask:0xf bank_mask:0xf
    v_add_f32_dpp v16, v66, v16 quad_perm:[2,2,2,2] row_mask:0xf bank_mask:0xf
    v_add_f32_dpp v17, v70, v17 quad_perm:[2,2,2,2] row_mask:0xf bank_mask:0xf
    v_add_f32_dpp v18, v74, v18 quad_perm:[2,2,2,2] row_mask:0xf bank_mask:0xf
    v_add_f32_dpp v19, v78, v19 quad_perm:[2,2,2,2] row_mask:0xf bank_mask:0xf
    v_add_f32_dpp v20, v82, v20 quad_perm:[2,2,2,2] row_mask:0xf bank_mask:0xf
    v_add_f32_dpp v21, v86, v21 quad_perm:[2,2,2,2] row_mask:0xf bank_mask:0xf
    v_add_f32_dpp v22, v90, v22 quad_perm:[2,2,2,2] row_mask:0xf bank_mask:0xf
    v_add_f32_dpp v23, v94, v23 quad_perm:[2,2,2,2] row_mask:0xf bank_mask:0xf
    v_add_f32_dpp v24, v98, v24 quad_perm:[2,2,2,2] row_mask:0xf bank_mask:0xf
    v_add_f32_dpp v25, v102, v25 quad_perm:[2,2,2,2] row_mask:0xf bank_mask:0xf
    v_add_f32_dpp v26, v106, v26 quad_perm:[2,2,2,2] row_mask:0xf bank_mask:0xf
    v_add_f32_dpp v27, v110, v27 quad_perm:[2,2,2,2] row_mask:0xf bank_mask:0xf
    v_add_f32_dpp v28, v114, v28 quad_perm:[2,2,2,2] row_mask:0xf bank_mask:0xf
    v_add_f32_dpp v29, v118, v29 quad_perm:[2,2,2,2] row_mask:0xf bank_mask:0xf
    v_add_f32_dpp v30, v122, v30 quad_perm:[2,2,2,2] row_mask:0xf bank_mask:0xf
    v_add_f32_dpp v31, v126, v31 quad_perm:[2,2,2,2] row_mask:0xf bank_mask:0xf
    v_add_f32_dpp v16, v67, v16 quad_perm:[3,3,3,3] row_mask:0xf bank_mask:0xf
    v_add_f32_dpp v17, v71, v17 quad_perm:[3,3,3,3] row_mask:0xf bank_mask:0xf
    v_add_f32_dpp v18, v75, v18 quad_perm:[3,3,3,3] row_mask:0xf bank_mask:0xf
    v_add_f32_dpp v19, v79, v19 quad_perm:[3,3,3,3] row_mask:0xf bank_mask:0xf
    v_add_f32_dpp v20, v83, v20 quad_perm:[3,3,3,3] row_mask:0xf bank_mask:0xf
    v_add_f32_dpp v21, v87, v21 quad_perm:[3,3,3,3] row_mask:0xf bank_mask:0xf
    v_add_f32_dpp v22, v91, v22 quad_perm:[3,3,3,3] row_mask:0xf bank_mask:0xf
    v_add_f32_dpp v23, v95, v23 quad_perm:[3,3,3,3] row_mask:0xf bank_mask:0xf
    v_add_f32_dpp v24, v99, v24 quad_perm:[3,3,3,3] row_mask:0xf bank_mask:0xf
    v_add_f32_dpp v25, v103, v25 quad_perm:[3,3,3,3] row_mask:0xf bank_mask:0xf
    v_add_f32_dpp v26, v107, v26 quad_perm:[3,3,3,3] row_mask:0xf bank_mask:0xf
    v_add_f32_dpp v27, v111, v27 quad_perm:[3,3,3,3] row_mask:0xf bank_mask:0xf
    v_add_f32_dpp v28, v115, v28 quad_perm:[3,3,3,3] row_mask:0xf bank_mask:0xf
    v_add_f32_dpp v29, v119, v29 quad_perm:[3,3,3,3] row_mask:0xf bank_mask:0xf
    v_add_f32_dpp v30, v123, v30 quad_perm:[3,3,3,3] row_mask:0xf bank_mask:0xf
    v_add_f32_dpp v31, v127, v31 quad_perm:[3,3,3,3] row_mask:0xf bank_mask:0xf
    v_cvt_pk_bf16_f32 v32, v16, v17
    v_cvt_pk_bf16_f32 v33, v18, v19
    v_cvt_pk_bf16_f32 v34, v20, v21
    v_cvt_pk_bf16_f32 v35, v22, v23
    v_cvt_pk_bf16_f32 v36, v24, v25
    v_cvt_pk_bf16_f32 v37, v26, v27
    v_cvt_pk_bf16_f32 v38, v28, v29
    v_cvt_pk_bf16_f32 v39, v30, v31
    v_lshlrev_b32 v16, 16, v32
    v_and_b32 v17, s94, v32
    v_lshlrev_b32 v18, 16, v33
    v_and_b32 v19, s94, v33
    v_lshlrev_b32 v20, 16, v34
    v_and_b32 v21, s94, v34
    v_lshlrev_b32 v22, 16, v35
    v_and_b32 v23, s94, v35
    v_lshlrev_b32 v24, 16, v36
    v_and_b32 v25, s94, v36
    v_lshlrev_b32 v26, 16, v37
    v_and_b32 v27, s94, v37
    v_lshlrev_b32 v28, 16, v38
    v_and_b32 v29, s94, v38
    v_lshlrev_b32 v30, 16, v39
    v_and_b32 v31, s94, v39
    v_max3_f32 v40, v16, v17, v18
    v_max3_f32 v40, v40, v19, v20
    v_max3_f32 v40, v40, v21, v22
    v_max3_f32 v40, v40, v23, v24
    v_max3_f32 v40, v40, v25, v26
    v_max3_f32 v40, v40, v27, v28
    v_max3_f32 v40, v40, v29, v30
    v_max_f32 v40, v40, v31
    v_mov_b32 v42, v40
    s_nop 1
    v_permlane16_swap_b32 v40, v42
    v_max_f32 v40, v40, v42
    v_mov_b32 v42, v40
    s_nop 1
    v_permlane32_swap_b32 v40, v42
    v_max_f32 v40, v40, v42
    v_sub_f32 v16, v16, v40
    v_sub_f32 v17, v17, v40
    v_sub_f32 v18, v18, v40
    v_sub_f32 v19, v19, v40
    v_sub_f32 v20, v20, v40
    v_sub_f32 v21, v21, v40
    v_sub_f32 v22, v22, v40
    v_sub_f32 v23, v23, v40
    v_sub_f32 v24, v24, v40
    v_sub_f32 v25, v25, v40
    v_sub_f32 v26, v26, v40
    v_sub_f32 v27, v27, v40
    v_sub_f32 v28, v28, v40
    v_sub_f32 v29, v29, v40
    v_sub_f32 v30, v30, v40
    v_sub_f32 v31, v31, v40
    v_mul_f32 v16, s41, v16
    v_mul_f32 v17, s41, v17
    v_mul_f32 v18, s41, v18
    v_mul_f32 v19, s41, v19
    v_mul_f32 v20, s41, v20
    v_mul_f32 v21, s41, v21
    v_mul_f32 v22, s41, v22
    v_mul_f32 v23, s41, v23
    v_mul_f32 v24, s41, v24
    v_mul_f32 v25, s41, v25
    v_mul_f32 v26, s41, v26
    v_mul_f32 v27, s41, v27
    v_mul_f32 v28, s41, v28
    v_mul_f32 v29, s41, v29
    v_mul_f32 v30, s41, v30
    v_mul_f32 v31, s41, v31
    v_exp_f32 v16, v16
    v_exp_f32 v17, v17
    v_exp_f32 v18, v18
    v_exp_f32 v19, v19
    v_exp_f32 v20, v20
    v_exp_f32 v21, v21
    v_exp_f32 v22, v22
    v_exp_f32 v23, v23
    v_exp_f32 v24, v24
    v_exp_f32 v25, v25
    v_exp_f32 v26, v26
    v_exp_f32 v27, v27
    v_exp_f32 v28, v28
    v_exp_f32 v29, v29
    v_exp_f32 v30, v30
    v_exp_f32 v31, v31
    v_mul_f32 v40, s41, v40
    v_add_f32 v41, v16, v17
    v_add_f32 v41, v41, v18
    v_add_f32 v41, v41, v19
    v_add_f32 v41, v41, v20
    v_add_f32 v41, v41, v21
    v_add_f32 v41, v41, v22
    v_add_f32 v41, v41, v23
    v_add_f32 v41, v41, v24
    v_add_f32 v41, v41, v25
    v_add_f32 v41, v41, v26
    v_add_f32 v41, v41, v27
    v_add_f32 v41, v41, v28
    v_add_f32 v41, v41, v29
    v_add_f32 v41, v41, v30
    v_add_f32 v41, v41, v31
    v_mov_b32 v42, v41
    s_nop 1
    v_permlane16_swap_b32 v41, v42
    v_add_f32 v41, v41, v42
    v_mov_b32 v42, v41
    s_nop 1
    v_permlane32_swap_b32 v41, v42
    v_add_f32 v41, v41, v42
    v_cvt_pk_bf16_f32 v16, v16, v16
    v_cvt_pk_bf16_f32 v17, v17, v17
    v_cvt_pk_bf16_f32 v18, v18, v18
    v_cvt_pk_bf16_f32 v19, v19, v19
    v_cvt_pk_bf16_f32 v20, v20, v20
    v_cvt_pk_bf16_f32 v21, v21, v21
    v_cvt_pk_bf16_f32 v22, v22, v22
    v_cvt_pk_bf16_f32 v23, v23, v23
    v_cvt_pk_bf16_f32 v24, v24, v24
    v_cvt_pk_bf16_f32 v25, v25, v25
    v_cvt_pk_bf16_f32 v26, v26, v26
    v_cvt_pk_bf16_f32 v27, v27, v27
    v_cvt_pk_bf16_f32 v28, v28, v28
    v_cvt_pk_bf16_f32 v29, v29, v29
    v_cvt_pk_bf16_f32 v30, v30, v30
    v_cvt_pk_bf16_f32 v31, v31, v31
    s_lshl_b32 s38, s28, 12
    v_lshl_add_u32 v7, v0, 4, s38
    s_lshl_b32 s38, s28, 3
    v_lshl_add_u32 v12, v4, 5, s38
    ds_write_b128 v7, v[16:19] offset:8192
    ds_write_b128 v7, v[20:23] offset:9216
    ds_write_b128 v7, v[24:27] offset:10240
Lpad7:
    s_cbranch_execz Lpad10
    ds_write_b128 v7, v[28:31] offset:11264
    ds_write_b64 v12, v[40:41] offset:1792
    s_lshr_b32 s38, s28, 1
    s_lshl_b32 s39, s38, 5
    v_mov_b32 v12, s39
    s_lshl_b32 s39, s28, 9
    v_lshl_add_u32 v13, v0, 3, s39
    s_lshl_b32 s39, s28, 8
    v_lshl_add_u32 v7, v0, 2, s39
    v_lshrrev_b32 v14, 5, v7
    v_lshlrev_b32 v14, 9, v14
    v_and_b32 v7, 31, v7
    s_lshl_b32 s39, s42, 14
    s_lshl_b32 s43, s32, 5
    s_add_u32 s39, s39, s43
    s_add_u32 s39, s39, 131072
    s_add_u32 s39, s39, s49
    v_add3_u32 v14, v14, v7, s39
    s_lshl_b32 s39, s42, 7
    s_lshl_b32 s38, s38, 6
    s_add_u32 s39, s39, s38
    s_lshl_b32 s38, s32, 2
    s_add_u32 s39, s39, s38
    s_add_u32 s39, s39, 393216
    s_add_u32 s39, s39, s49
    v_mov_b32 v15, s39
    v_and_b32 v7, 1, v3
    s_cmp_lg_u32 s95, 2
    s_cbranch_scc1 L_nopc
    s_mul_i32 s38, s44, 7168
    s_mul_i32 s39, s28, 1792
    s_add_u32 s38, s38, s39
    s_add_u32 s38, s38, 737280
    v_lshl_add_u32 v8, v0, 4, s38
    v_mov_b32 v48, -1
    v_mov_b32 v49, -1
    v_mov_b32 v50, -1
    v_mov_b32 v51, -1
    global_store_dwordx4 v8, v[48:51], s[26:27] sc1
    s_mov_b32 exec_hi, 0xffff
    global_store_dwordx4 v8, v[48:51], s[26:27] offset:1024 sc1
    s_mov_b32 exec_hi, -1
L_nopc:
    s_waitcnt lgkmcnt(0)
    s_barrier
    ds_read_b128 v[16:19], v12 offset:1792
    ds_read_b128 v[20:23], v12 offset:1808
    s_waitcnt lgkmcnt(0)
    v_max3_f32 v24, v16, v18, v20
    v_max_f32 v24, v24, v22
    v_sub_f32 v16, v16, v24
    v_sub_f32 v18, v18, v24
    v_sub_f32 v20, v20, v24
    v_sub_f32 v22, v22, v24
    v_exp_f32 v16, v16
    v_exp_f32 v18, v18
    v_exp_f32 v20, v20
    v_exp_f32 v22, v22
    v_mul_f32 v25, v16, v17
    v_fmac_f32 v25, v18, v19
    v_fmac_f32 v25, v20, v21
    v_fmac_f32 v25, v22, v23
    v_rcp_f32 v26, v25
    v_log_f32 v25, v25
    v_mul_f32 v16, v16, v26
    v_mul_f32 v18, v18, v26
    v_mul_f32 v20, v20, v26
    v_mul_f32 v22, v22, v26
    v_add_f32 v25, v25, v24
    v_min_u32 v25, -2, v25
    s_bitcmp1_b32 s28, 0
    s_cbranch_scc1 L_nolse
    s_mov_b64 exec, 1
    s_cmp_eq_u32 s49, 0
    s_cbranch_scc1 L_lsefast
    global_store_dword v15, v25, s[26:27] sc1
    s_branch L_nolse
L_lsefast:
    global_store_dword v15, v25, s[26:27]
L_nolse:
    s_mov_b64 exec, -1
    s_cmp_ge_u32 s30, 14
    s_cbranch_scc1 L_knotwo
    s_waitcnt vmcnt(1)
    s_lshl_b32 s38, s29, 8
    s_lshr_b32 s39, s28, 1
    s_lshl_b32 s39, s39, 6
    s_add_u32 s38, s38, s39
    s_add_u32 s38, s38, 393216
    s_add_u32 s38, s38, s49
    v_lshl_add_u32 v130, v3, 4, s38
    v_lshlrev_b32 v131, 9, v3
    v_lshrrev_b32 v4, 2, v2
    v_lshl_add_u32 v131, v4, 6, v131
    v_lshl_add_u32 v131, v5, 3, v131
    s_lshl_b32 s38, s28, 13
    s_add_u32 s38, s38, 49152
    v_add_u32 v131, s38, v131
    s_lshl_b32 s38, s29, 15
    s_add_u32 s38, s38, 131072
    s_add_u32 s38, s38, s49
    s_lshl_b32 s39, s28, 8
    v_lshl_add_u32 v4, v3, 4, s39
    v_lshrrev_b32 v128, 5, v4
    v_lshlrev_b32 v128, 9, v128
    v_and_b32 v4, 31, v4
    v_add3_u32 v128, v128, v4, s38
    v_lshl_add_u32 v128, v2, 5, v128
    v_xor_b32 v129, 0x4000, v128
    v_lshlrev_b32 v132, 9, v7
    v_lshrrev_b32 v4, 1, v3
    v_lshl_add_u32 v132, v4, 8, v132
    v_lshrrev_b32 v4, 1, v2
    v_lshl_add_u32 v132, v4, 5, v132
    v_and_b32 v4, 1, v2
    v_lshl_add_u32 v132, v4, 2, v132
    s_lshl_b32 s39, s28, 3
    v_add_u32 v132, s39, v132
    v_lshlrev_b32 v133, 5, v0
    s_lshl_b32 s38, s29, 7
    s_lshl_b32 s39, s32, 10
    s_add_u32 s38, s38, s39
    s_add_u32 s38, s38, 720896
    v_lshl_add_u32 v134, v0, 2, s38
    s_cmp_eq_u32 s29, 0
    s_cselect_b32 s38, -1, 0
    v_and_b32 v136, s38, v11
    v_and_b32 v137, s94, v136
    v_lshlrev_b32 v136, 16, v136
    s_barrier
    s_mov_b32 m0, s92
    s_nop 0
    global_load_lds_dwordx4 v44, s[12:13] offset:0
    v_add_u32 v44, 13312, v44
    global_load_lds_dwordx4 v44, s[12:13] offset:1024
    v_add_u32 v44, 13312, v44
    global_load_lds_dwordx4 v44, s[12:13] offset:2048
    v_add_u32 v44, 13312, v44
    global_load_lds_dwordx4 v44, s[12:13] offset:3072
    s_mov_b32 m0, s93
    s_nop 0
    global_load_lds_dwordx4 v45, s[12:13] offset:0
    v_add_u32 v45, 13312, v45
    global_load_lds_dwordx4 v45, s[12:13] offset:1024
    v_add_u32 v45, 13312, v45
    global_load_lds_dwordx4 v45, s[12:13] offset:2048
    v_add_u32 v45, 13312, v45
    global_load_lds_dwordx4 v45, s[12:13] offset:3072
    s_cmp_eq_u32 s49, 0
    s_waitcnt lgkmcnt(0)
    s_barrier
    ds_read_b64 v[24:25], v13 offset:24576
    ds_read_b64 v[26:27], v13 offset:26624
    ds_read_b64 v[28:29], v13 offset:28672
    ds_read_b64 v[30:31], v13 offset:30720
    s_waitcnt lgkmcnt(0)
    v_pk_mul_f32 v[24:25], v[24:25], v[16:17] op_sel_hi:[1,0]
    v_pk_mul_f32 v[28:29], v[28:29], v[20:21] op_sel_hi:[1,0]
    v_pk_fma_f32 v[24:25], v[26:27], v[18:19], v[24:25] op_sel_hi:[1,0,1]
    v_pk_fma_f32 v[28:29], v[30:31], v[22:23], v[28:29] op_sel_hi:[1,0,1]
    v_pk_add_f32 v[24:25], v[24:25], v[28:29]
    v_cvt_pk_bf16_f32 v24, v24, v25
    v_min_u32 v24, -2, v24
    s_cbranch_scc0 L_osloww
    global_store_dword v14, v24, s[26:27]
L_opubw:
    s_barrier
    global_load_dwordx4 v[176:179], v130, s[26:27] offset:0 sc1
    global_load_dwordx4 v[180:183], v130, s[26:27] offset:128 sc1
    global_load_dwordx4 v[160:163], v129, s[26:27] offset:0 sc1
    global_load_dwordx4 v[164:167], v129, s[26:27] offset:1024 sc1
    global_load_dwordx4 v[168:171], v129, s[26:27] offset:2048 sc1
    global_load_dwordx4 v[172:175], v129, s[26:27] offset:3072 sc1
    global_load_dwordx4 v[144:147], v128, s[26:27] offset:0 sc1
    global_load_dwordx4 v[148:151], v128, s[26:27] offset:1024 sc1
    global_load_dwordx4 v[152:155], v128, s[26:27] offset:2048 sc1
    global_load_dwordx4 v[156:159], v128, s[26:27] offset:3072 sc1
    s_waitcnt vmcnt(10)
    ds_read_b64_tr_b16 v[64:65], v131 offset:0
    ds_read_b64_tr_b16 v[66:67], v131 offset:256
    ds_read_b64_tr_b16 v[68:69], v131 offset:32
    ds_read_b64_tr_b16 v[70:71], v131 offset:288
    ds_read_b64_tr_b16 v[72:73], v131 offset:2048
    ds_read_b64_tr_b16 v[74:75], v131 offset:2304
Lpad8:
    s_cbranch_execz Lpad11
    ds_read_b64_tr_b16 v[76:77], v131 offset:2080
    ds_read_b64_tr_b16 v[78:79], v131 offset:2336
    ds_read_b64_tr_b16 v[80:81], v131 offset:4096
    ds_read_b64_tr_b16 v[82:83], v131 offset:4352
    ds_read_b64_tr_b16 v[84:85], v131 offset:4128
    ds_read_b64_tr_b16 v[86:87], v131 offset:4384
    ds_read_b64_tr_b16 v[88:89], v131 offset:6144
    ds_read_b64_tr_b16 v[90:91], v131 offset:6400
    ds_read_b64_tr_b16 v[92:93], v131 offset:6176
    ds_read_b64_tr_b16 v[94:95], v131 offset:6432
    s_mov_b32 s40, 131072
    s_waitcnt vmcnt(8)
    s_branch L_pl_chk
L_pl:
    s_sleep 1
    global_load_dwordx4 v[176:179], v130, s[26:27] offset:0 sc1
    global_load_dwordx4 v[180:183], v130, s[26:27] offset:128 sc1
    s_sub_u32 s40, s40, 1
    s_cbranch_scc1 L_pl_done
    s_waitcnt vmcnt(0)
L_pl_chk:
    v_max3_u32 v4, v176, v177, v178
    v_max3_u32 v4, v4, v179, v180
    v_max3_u32 v4, v4, v181, v182
    v_max_u32 v4, v4, v183
    v_cmp_eq_u32 vcc, -1, v4
    s_cbranch_vccnz L_pl
L_pl_done:
    v_max3_f32 v20, v176, v177, v178
    v_max_f32 v20, v20, v179
    v_max3_f32 v22, v180, v181, v182
    v_max_f32 v22, v22, v183
    v_mov_b32 v21, v20
    v_mov_b32 v23, v22
    s_nop 0
    v_permlane16_swap_b32 v20, v21
    v_permlane16_swap_b32 v22, v23
    v_max_f32 v20, v20, v21
    v_max_f32 v22, v22, v23
    v_mov_b32 v21, v20
    v_mov_b32 v23, v22
    s_nop 0
    v_permlane32_swap_b32 v20, v21
    v_permlane32_swap_b32 v22, v23
    v_max_f32 v20, v20, v21
    v_max_f32 v22, v22, v23
    v_sub_f32 v176, v176, v20
    v_sub_f32 v177, v177, v20
    v_sub_f32 v178, v178, v20
    v_sub_f32 v179, v179, v20
    v_exp_f32 v176, v176
    v_exp_f32 v177, v177
    v_exp_f32 v178, v178
    v_exp_f32 v179, v179
    v_add_f32 v20, v176, v177
    v_add_f32 v21, v178, v179
    v_add_f32 v20, v20, v21
    v_sub_f32 v180, v180, v22
    v_sub_f32 v181, v181, v22
    v_sub_f32 v182, v182, v22
    v_sub_f32 v183, v183, v22
    v_exp_f32 v180, v180
    v_exp_f32 v181, v181
    v_exp_f32 v182, v182
    v_exp_f32 v183, v183
    v_add_f32 v22, v180, v181
    v_add_f32 v23, v182, v183
    v_add_f32 v22, v22, v23
    v_mov_b32 v21, v20
    v_mov_b32 v23, v22
    s_nop 0
    v_permlane16_swap_b32 v20, v21
    v_permlane16_swap_b32 v22, v23
    v_add_f32 v20, v20, v21
    v_add_f32 v22, v22, v23
    v_mov_b32 v21, v20
    v_mov_b32 v23, v22
    s_nop 0
    v_permlane32_swap_b32 v20, v21
    v_permlane32_swap_b32 v22, v23
    v_add_f32 v20, v20, v21
    v_add_f32 v22, v22, v23
    v_rcp_f32 v20, v20
    v_rcp_f32 v22, v22
    v_mul_f32 v176, v176, v20
    v_mul_f32 v177, v177, v20
    v_mul_f32 v178, v178, v20
    v_mul_f32 v179, v179, v20
    v_mul_f32 v180, v180, v22
    v_mul_f32 v181, v181, v22
    v_mul_f32 v182, v182, v22
    v_mul_f32 v183, v183, v22
    s_waitcnt lgkmcnt(0)
L_pb_chk:
    s_waitcnt vmcnt(0)
    v_max3_u32 v4, v144, v145, v146
    v_max3_u32 v4, v4, v147, v148
    v_max3_u32 v4, v4, v149, v150
    v_max3_u32 v4, v4, v151, v152
    v_max3_u32 v4, v4, v153, v154
    v_max3_u32 v4, v4, v155, v156
    v_max3_u32 v4, v4, v157, v158
    v_max_u32 v4, v4, v159
    v_cmp_eq_u32 s[84:85], -1, v4
    v_max3_u32 v4, v160, v161, v162
    v_max3_u32 v4, v4, v163, v164
    v_max3_u32 v4, v4, v165, v166
    v_max3_u32 v4, v4, v167, v168
    v_max3_u32 v4, v4, v169, v170
    v_max3_u32 v4, v4, v171, v172
    v_max3_u32 v4, v4, v173, v174
    v_max_u32 v4, v4, v175
    v_cmp_eq_u32 vcc, -1, v4
    s_cbranch_vccz L_b1done
    s_cmp_eq_u64 s[84:85], 0
    s_cbranch_scc1 L_b0done
    s_mov_b64 exec, vcc
    global_load_dwordx4 v[160:163], v129, s[26:27] offset:0 sc1
    global_load_dwordx4 v[164:167], v129, s[26:27] offset:1024 sc1
    global_load_dwordx4 v[168:171], v129, s[26:27] offset:2048 sc1
    global_load_dwordx4 v[172:175], v129, s[26:27] offset:3072 sc1
    s_mov_b64 exec, s[84:85]
    global_load_dwordx4 v[144:147], v128, s[26:27] offset:0 sc1
    global_load_dwordx4 v[148:151], v128, s[26:27] offset:1024 sc1
    global_load_dwordx4 v[152:155], v128, s[26:27] offset:2048 sc1
    global_load_dwordx4 v[156:159], v128, s[26:27] offset:3072 sc1
    s_mov_b64 exec, -1
    s_sub_u32 s40, s40, 1
    s_cbranch_scc0 L_pb_chk
L_b0done:
    s_mov_b64 exec, vcc
    global_load_dwordx4 v[160:163], v129, s[26:27] offset:0 sc1
    global_load_dwordx4 v[164:167], v129, s[26:27] offset:1024 sc1
    global_load_dwordx4 v[168:171], v129, s[26:27] offset:2048 sc1
    global_load_dwordx4 v[172:175], v129, s[26:27] offset:3072 sc1
    s_mov_b64 exec, -1
    v_mfma_f32_16x16x32_bf16 v[32:35], v[144:147], v[64:67], 0
    v_mfma_f32_16x16x32_bf16 v[36:39], v[144:147], v[68:71], 0
    v_mfma_f32_16x16x32_bf16 v[32:35], v[148:151], v[72:75], v[32:35]
    v_mfma_f32_16x16x32_bf16 v[36:39], v[148:151], v[76:79], v[36:39]
    v_mfma_f32_16x16x32_bf16 v[32:35], v[152:155], v[80:83], v[32:35]
    v_mfma_f32_16x16x32_bf16 v[36:39], v[152:155], v[84:87], v[36:39]
    v_mfma_f32_16x16x32_bf16 v[32:35], v[156:159], v[88:91], v[32:35]
    v_mfma_f32_16x16x32_bf16 v[36:39], v[156:159], v[92:95], v[36:39]
    s_nop 6
    v_mul_f32 v24, v32, v176
    v_mul_f32 v25, v36, v176
    v_fmac_f32 v24, v33, v177
    v_fmac_f32 v25, v37, v177
    v_fmac_f32 v24, v34, v178
    v_fmac_f32 v25, v38, v178
    v_fmac_f32 v24, v35, v179
    v_fmac_f32 v25, v39, v179
    s_nop 1
    v_permlane32_swap_b32 v24, v25
    v_add_f32 v24, v24, v25
    s_mov_b32 s40, 131072
    s_branch L_po1_chk
L_po1:
    global_load_dwordx4 v[160:163], v129, s[26:27] offset:0 sc1
    global_load_dwordx4 v[164:167], v129, s[26:27] offset:1024 sc1
    global_load_dwordx4 v[168:171], v129, s[26:27] offset:2048 sc1
    global_load_dwordx4 v[172:175], v129, s[26:27] offset:3072 sc1
    s_sub_u32 s40, s40, 1
    s_cbranch_scc1 L_po1_done
L_po1_chk:
    s_waitcnt vmcnt(0)
    v_max3_u32 v4, v160, v161, v162
    v_max3_u32 v4, v4, v163, v164
    v_max3_u32 v4, v4, v165, v166
    v_max3_u32 v4, v4, v167, v168
    v_max3_u32 v4, v4, v169, v170
    v_max3_u32 v4, v4, v171, v172
    v_max3_u32 v4, v4, v173, v174
    v_max_u32 v4, v4, v175
    v_cmp_eq_u32 vcc, -1, v4
    s_and_b64 exec, exec, vcc
    s_cbranch_scc1 L_po1
L_po1_done:
    s_mov_b64 exec, -1
    v_mfma_f32_16x16x32_bf16 v[40:43], v[160:163], v[64:67], 0
    v_mfma_f32_16x16x32_bf16 v[44:47], v[160:163], v[68:71], 0
    v_mfma_f32_16x16x32_bf16 v[40:43], v[164:167], v[72:75], v[40:43]
    v_mfma_f32_16x16x32_bf16 v[44:47], v[164:167], v[76:79], v[44:47]
    v_mfma_f32_16x16x32_bf16 v[40:43], v[168:171], v[80:83], v[40:43]
    v_mfma_f32_16x16x32_bf16 v[44:47], v[168:171], v[84:87], v[44:47]
    v_mfma_f32_16x16x32_bf16 v[40:43], v[172:175], v[88:91], v[40:43]
    v_mfma_f32_16x16x32_bf16 v[44:47], v[172:175], v[92:95], v[44:47]
    s_nop 6
Lpad9:
    s_cbranch_execz Lpad12
    v_mul_f32 v26, v40, v180
    v_mul_f32 v27, v44, v180
    v_fmac_f32 v26, v41, v181
    v_fmac_f32 v27, v45, v181
    v_fmac_f32 v26, v42, v182
    v_fmac_f32 v27, v46, v182
    v_fmac_f32 v26, v43, v183
    v_fmac_f32 v27, v47, v183
    s_nop 1
    v_permlane32_swap_b32 v26, v27
    v_add_f32 v26, v26, v27
    s_branch L_wojoin
L_b1done:
    s_cmp_eq_u64 s[84:85], 0
    s_cbranch_scc1 L_bothdone
    s_mov_b64 exec, s[84:85]
    global_load_dwordx4 v[144:147], v128, s[26:27] offset:0 sc1
    global_load_dwordx4 v[148:151], v128, s[26:27] offset:1024 sc1
    global_load_dwordx4 v[152:155], v128, s[26:27] offset:2048 sc1
    global_load_dwordx4 v[156:159], v128, s[26:27] offset:3072 sc1
    s_mov_b64 exec, -1
    v_mfma_f32_16x16x32_bf16 v[40:43], v[160:163], v[64:67], 0
    v_mfma_f32_16x16x32_bf16 v[44:47], v[160:163], v[68:71], 0
    v_mfma_f32_16x16x32_bf16 v[40:43], v[164:167], v[72:75], v[40:43]
    v_mfma_f32_16x16x32_bf16 v[44:47], v[164:167], v[76:79], v[44:47]
    v_mfma_f32_16x16x32_bf16 v[40:43], v[168:171], v[80:83], v[40:43]
    v_mfma_f32_16x16x32_bf16 v[44:47], v[168:171], v[84:87], v[44:47]
    v_mfma_f32_16x16x32_bf16 v[40:43], v[172:175], v[88:91], v[40:43]
    v_mfma_f32_16x16x32_bf16 v[44:47], v[172:175], v[92:95], v[44:47]
    s_nop 6
    v_mul_f32 v26, v40, v180
    v_mul_f32 v27, v44, v180
    v_fmac_f32 v26, v41, v181
    v_fmac_f32 v27, v45, v181
    v_fmac_f32 v26, v42, v182
    v_fmac_f32 v27, v46, v182
    v_fmac_f32 v26, v43, v183
    v_fmac_f32 v27, v47, v183
    s_nop 1
    v_permlane32_swap_b32 v26, v27
    v_add_f32 v26, v26, v27
    s_mov_b32 s40, 131072
    s_branch L_po0_chk
L_po0:
    global_load_dwordx4 v[144:147], v128, s[26:27] offset:0 sc1
    global_load_dwordx4 v[148:151], v128, s[26:27] offset:1024 sc1
    global_load_dwordx4 v[152:155], v128, s[26:27] offset:2048 sc1
    global_load_dwordx4 v[156:159], v128, s[26:27] offset:3072 sc1
    s_sub_u32 s40, s40, 1
    s_cbranch_scc1 L_po0_done
L_po0_chk:
    s_waitcnt vmcnt(0)
    v_max3_u32 v4, v144, v145, v146
    v_max3_u32 v4, v4, v147, v148
    v_max3_u32 v4, v4, v149, v150
    v_max3_u32 v4, v4, v151, v152
    v_max3_u32 v4, v4, v153, v154
    v_max3_u32 v4, v4, v155, v156
    v_max3_u32 v4, v4, v157, v158
    v_max_u32 v4, v4, v159
    v_cmp_eq_u32 vcc, -1, v4
    s_and_b64 exec, exec, vcc
    s_cbranch_scc1 L_po0
L_po0_done:
    s_mov_b64 exec, -1
    v_mfma_f32_16x16x32_bf16 v[32:35], v[144:147], v[64:67], 0
    v_mfma_f32_16x16x32_bf16 v[36:39], v[144:147], v[68:71], 0
    v_mfma_f32_16x16x32_bf16 v[32:35], v[148:151], v[72:75], v[32:35]
    v_mfma_f32_16x16x32_bf16 v[36:39], v[148:151], v[76:79], v[36:39]
    v_mfma_f32_16x16x32_bf16 v[32:35], v[152:155], v[80:83], v[32:35]
    v_mfma_f32_16x16x32_bf16 v[36:39], v[152:155], v[84:87], v[36:39]
    v_mfma_f32_16x16x32_bf16 v[32:35], v[156:159], v[88:91], v[32:35]
    v_mfma_f32_16x16x32_bf16 v[36:39], v[156:159], v[92:95], v[36:39]
    s_nop 6
    v_mul_f32 v24, v32, v176
    v_mul_f32 v25, v36, v176
    v_fmac_f32 v24, v33, v177
    v_fmac_f32 v25, v37, v177
    v_fmac_f32 v24, v34, v178
    v_fmac_f32 v25, v38, v178
    v_fmac_f32 v24, v35, v179
    v_fmac_f32 v25, v39, v179
    s_nop 1
    v_permlane32_swap_b32 v24, v25
    v_add_f32 v24, v24, v25
    s_branch L_wojoin
L_bothdone:
    v_mfma_f32_16x16x32_bf16 v[32:35], v[144:147], v[64:67], 0
    v_mfma_f32_16x16x32_bf16 v[36:39], v[144:147], v[68:71], 0
    v_mfma_f32_16x16x32_bf16 v[32:35], v[148:151], v[72:75], v[32:35]
    v_mfma_f32_16x16x32_bf16 v[36:39], v[148:151], v[76:79], v[36:39]
    v_mfma_f32_16x16x32_bf16 v[32:35], v[152:155], v[80:83], v[32:35]
    v_mfma_f32_16x16x32_bf16 v[36:39], v[152:155], v[84:87], v[36:39]
    v_mfma_f32_16x16x32_bf16 v[32:35], v[156:159], v[88:91], v[32:35]
    v_mfma_f32_16x16x32_bf16 v[36:39], v[156:159], v[92:95], v[36:39]
    v_mfma_f32_16x16x32_bf16 v[40:43], v[160:163], v[64:67], 0
    v_mfma_f32_16x16x32_bf16 v[44:47], v[160:163], v[68:71], 0
    v_mfma_f32_16x16x32_bf16 v[40:43], v[164:167], v[72:75], v[40:43]
    v_mfma_f32_16x16x32_bf16 v[44:47], v[164:167], v[76:79], v[44:47]
    v_mfma_f32_16x16x32_bf16 v[40:43], v[168:171], v[80:83], v[40:43]
    v_mfma_f32_16x16x32_bf16 v[44:47], v[168:171], v[84:87], v[44:47]
    v_mfma_f32_16x16x32_bf16 v[40:43], v[172:175], v[88:91], v[40:43]
    v_mfma_f32_16x16x32_bf16 v[44:47], v[172:175], v[92:95], v[44:47]
    v_mul_f32 v24, v32, v176
    v_mul_f32 v25, v36, v176
    v_fmac_f32 v24, v33, v177
    v_fmac_f32 v25, v37, v177
    v_fmac_f32 v24, v34, v178
    v_fmac_f32 v25, v38, v178
    v_fmac_f32 v24, v35, v179
    v_fmac_f32 v25, v39, v179
    s_nop 1
    v_permlane32_swap_b32 v24, v25
    v_add_f32 v24, v24, v25
    v_mul_f32 v26, v40, v180
    v_mul_f32 v27, v44, v180
    v_fmac_f32 v26, v41, v181
    v_fmac_f32 v27, v45, v181
    v_fmac_f32 v26, v42, v182
    v_fmac_f32 v27, v46, v182
    v_fmac_f32 v26, v43, v183
    v_fmac_f32 v27, v47, v183
    s_nop 1
    v_permlane32_swap_b32 v26, v27
    v_add_f32 v26, v26, v27
L_wojoin:
    s_cmp_lg_u32 s28, 0
    s_nop 0
    v_permlane16_swap_b32 v24, v26
    v_add_f32 v24, v24, v26
    ds_write_b32 v132, v24 offset:2048
    s_mov_b32 exec_hi, 0
    s_waitcnt lgkmcnt(0)
    s_barrier
    s_cbranch_scc1 L_end2
    ds_read_b128 v[16:19], v133 offset:2048
    ds_read_b128 v[20:23], v133 offset:2064
    s_waitcnt lgkmcnt(0)
    v_pk_add_f32 v[16:17], v[16:17], v[18:19]
    v_pk_add_f32 v[20:21], v[20:21], v[22:23]
    v_pk_add_f32 v[16:17], v[16:17], v[136:137]
    v_pk_add_f32 v[16:17], v[16:17], v[20:21]
    v_cvt_pk_bf16_f32 v16, v16, v17
    v_min_u32 v16, -2, v16
    global_store_dword v134, v16, s[26:27] sc1
L_end2:
    s_endpgm
L_osloww:
    global_store_dword v14, v24, s[26:27] sc1
    s_lshl_b32 s38, s29, 7
    s_lshl_b32 s39, s30, 2
    s_add_u32 s39, s39, s38
    v_mov_b32 v4, s39
    v_mov_b32 v6, s33
    s_waitcnt vmcnt(0)
    s_barrier
    s_cmp_lg_u32 s28, 0
    s_cbranch_scc1 L_osl1w
    global_store_dword v4, v6, s[26:27] offset:3072 sc1
L_osl1w:
    v_and_b32 v4, 31, v0
    v_lshl_add_u32 v4, v4, 2, s38
    s_mov_b32 s40, 131072
L_osl2:
    global_load_dword v6, v4, s[26:27] offset:3072 sc1
    s_sub_u32 s40, s40, 1
    s_cbranch_scc1 L_opubw
    s_waitcnt vmcnt(0)
    v_cmp_ne_u32 vcc, s33, v6
    s_sleep 2
    s_cbranch_vccnz L_osl2
    s_branch L_opubw
L_knotwo:
    v_and_b32 v120, 7, v0
    v_lshlrev_b32 v120, 7, v120
    v_add_u32 v120, 4096, v120
    global_load_dword v121, v120, s[26:27] sc1
    s_cmp_ge_u32 s95, 2
    s_cbranch_scc1 L_kfinal
    s_mul_i32 s39, s28, 3584
    v_lshlrev_b32 v6, 8, v3
    v_lshl_add_u32 v6, v2, 3, v6
    s_add_u32 s38, s39, 49152
    v_add_u32 v118, s38, v6
    v_lshlrev_b32 v8, 8, v7
    v_lshl_add_u32 v8, v2, 3, v8
    v_add_u32 v8, s38, v8
    s_lshl_b32 s38, s28, 3
    v_lshl_add_u32 v40, v2, 5, s38
    v_lshlrev_b32 v41, 5, v2
    s_mul_i32 s38, s28, 112
    v_lshl_add_u32 v9, v3, 3, s38
    v_lshl_add_u32 v10, v7, 3, s38
    v_lshlrev_b32 v42, 6, v2
Lpad10:
    s_cbranch_execz Lpad13
    v_add_u32 v42, 720896, v42
    v_lshrrev_b32 v4, 5, v9
    v_and_b32 v9, 31, v9
    v_lshl_add_u32 v9, v9, 1, v42
    v_lshl_add_u32 v9, v4, 10, v9
    v_lshrrev_b32 v4, 5, v10
    v_and_b32 v10, 31, v10
    v_lshl_add_u32 v10, v10, 1, v42
    v_lshl_add_u32 v10, v4, 10, v10
    v_mov_b32 v96, 0x3f803f80
    v_mov_b32 v97, v96
    v_mov_b32 v98, v96
    v_mov_b32 v99, v96
    v_mov_b32 v100, v96
    v_mov_b32 v101, v96
    v_mov_b32 v102, v96
    v_mov_b32 v103, v96
    v_and_b32 v4, 1, v2
    v_lshlrev_b32 v4, 4, v4
    v_mov_b32 v6, 0xffff
    v_lshlrev_b32 v6, v4, v6
    v_bfe_u32 v4, v2, 1, 2
    v_cmp_eq_u32 vcc, 0, v4
    s_nop 1
    v_cndmask_b32 v122, 0, v6, vcc
    v_cmp_eq_u32 vcc, 1, v4
    s_nop 1
    v_cndmask_b32 v123, 0, v6, vcc
    v_cmp_eq_u32 vcc, 2, v4
    s_nop 1
    v_cndmask_b32 v124, 0, v6, vcc
    v_cmp_eq_u32 vcc, 3, v4
    s_nop 1
    v_cndmask_b32 v125, 0, v6, vcc
    s_lshl_b32 s38, s28, 8
    v_lshl_add_u32 v119, v0, 2, s38
    v_lshrrev_b32 v42, 3, v2
    v_lshlrev_b32 v42, 7, v42
    v_lshl_add_u32 v117, v3, 4, v42
    v_lshrrev_b32 v4, 1, v3
    v_mul_u32_u24 v4, 14, v4
    v_lshrrev_b32 v42, 2, v2
    v_add_u32 v4, v4, v42
    v_mul_u32_u24 v4, 7168, v4
    v_lshl_add_u32 v4, v5, 4, v4
    s_and_b32 s43, s46, 0xffff
    s_mul_i32 s38, s28, 28672
    s_lshl_b32 s41, s45, 6
    s_add_u32 s38, s38, s41
    s_add_u32 s38, s38, 737280
    v_add_u32 v116, s38, v4
    s_mov_b32 s40, 131072
    s_branch L_grf_chk
L_grf:
    s_sleep 2
    global_load_dword v121, v120, s[26:27] sc1
    s_sub_u32 s40, s40, 1
    s_cbranch_scc1 L_grf_done
L_grf_chk:
    s_waitcnt vmcnt(0)
    v_cmp_ne_u32 vcc, s33, v121
    s_cbranch_vccnz L_grf
L_grf_done:
    s_barrier
    s_mov_b32 exec_lo, s46
    s_mov_b32 exec_hi, s46
    global_load_dwordx4 v[48:51], v43, s[20:21] offset:0 nt
    global_load_dwordx4 v[52:55], v43, s[20:21] offset:896 nt
    global_load_dwordx4 v[56:59], v43, s[20:21] offset:1792 nt
    global_load_dwordx4 v[60:63], v43, s[20:21] offset:2688 nt
    s_mov_b64 exec, -1
    s_cmp_eq_u32 s49, 0
    s_waitcnt lgkmcnt(0)
    s_barrier
    ds_read_b64 v[24:25], v13 offset:24576
    ds_read_b64 v[26:27], v13 offset:26624
    ds_read_b64 v[28:29], v13 offset:28672
    ds_read_b64 v[30:31], v13 offset:30720
    s_waitcnt lgkmcnt(0)
    v_pk_mul_f32 v[24:25], v[24:25], v[16:17] op_sel_hi:[1,0]
    v_pk_mul_f32 v[28:29], v[28:29], v[20:21] op_sel_hi:[1,0]
    v_pk_fma_f32 v[24:25], v[26:27], v[18:19], v[24:25] op_sel_hi:[1,0,1]
    v_pk_fma_f32 v[28:29], v[30:31], v[22:23], v[28:29] op_sel_hi:[1,0,1]
    v_pk_add_f32 v[24:25], v[24:25], v[28:29]
    v_cvt_pk_bf16_f32 v24, v24, v25
    v_min_u32 v24, -2, v24
    s_cbranch_scc0 L_oslowf
    global_store_dword v14, v24, s[26:27]
L_opubf:
    s_barrier
    s_mov_b32 exec_hi, s88
    s_add_u32 m0, s84, 49152
    s_nop 0
    global_load_lds_dwordx4 v44, s[16:17]
    s_add_u32 m0, s84, 63488
    s_nop 0
    global_load_lds_dwordx4 v44, s[18:19]
    s_mov_b32 exec_hi, -1
    s_mov_b32 exec_hi, s89
    s_add_u32 m0, s85, 49152
    s_nop 0
    global_load_lds_dwordx4 v45, s[16:17]
    s_add_u32 m0, s85, 63488
    s_nop 0
    global_load_lds_dwordx4 v45, s[18:19]
    s_mov_b32 exec_hi, -1
    s_mov_b32 exec_hi, s90
    s_add_u32 m0, s86, 49152
    s_nop 0
    global_load_lds_dwordx4 v46, s[16:17]
    s_add_u32 m0, s86, 63488
    s_nop 0
    global_load_lds_dwordx4 v46, s[18:19]
    s_mov_b32 exec_hi, -1
    s_mov_b32 exec_hi, s91
    s_add_u32 m0, s87, 49152
    s_nop 0
    global_load_lds_dwordx4 v47, s[16:17]
    s_add_u32 m0, s87, 63488
    s_nop 0
    global_load_lds_dwordx4 v47, s[18:19]
    s_mov_b32 exec_hi, -1
    global_load_dwordx4 v[128:131], v9, s[26:27] offset:0 sc1
    global_load_dwordx4 v[132:135], v9, s[26:27] offset:1024 sc1
    global_load_dwordx4 v[136:139], v9, s[26:27] offset:2048 sc1
    global_load_dwordx4 v[140:143], v10, s[26:27] offset:3072 sc1
    s_waitcnt vmcnt(4)
    ds_read_b64_tr_b16 v[64:65], v118 offset:0
    ds_read_b64_tr_b16 v[66:67], v118 offset:128
    ds_read_b64_tr_b16 v[68:69], v118 offset:1024
    ds_read_b64_tr_b16 v[70:71], v118 offset:1152
    ds_read_b64_tr_b16 v[72:73], v118 offset:2048
    ds_read_b64_tr_b16 v[74:75], v118 offset:2176
    ds_read_b64_tr_b16 v[76:77], v8 offset:3072
    ds_read_b64_tr_b16 v[78:79], v8 offset:3200
    ds_read_b64_tr_b16 v[80:81], v118 offset:14336
    ds_read_b64_tr_b16 v[82:83], v118 offset:14464
    ds_read_b64_tr_b16 v[84:85], v118 offset:15360
    ds_read_b64_tr_b16 v[86:87], v118 offset:15488
    ds_read_b64_tr_b16 v[88:89], v118 offset:16384
    ds_read_b64_tr_b16 v[90:91], v118 offset:16512
    ds_read_b64_tr_b16 v[92:93], v8 offset:17408
    ds_read_b64_tr_b16 v[94:95], v8 offset:17536
    s_waitcnt lgkmcnt(0)
    s_mov_b32 exec_lo, 0
    v_mov_b32 v76, 0
    v_mov_b32 v92, 0
    v_mov_b32 v100, 0
    v_mov_b32 v77, 0
    v_mov_b32 v93, 0
    v_mov_b32 v101, 0
    v_mov_b32 v78, 0
    v_mov_b32 v94, 0
    v_mov_b32 v102, 0
    v_mov_b32 v79, 0
    v_mov_b32 v95, 0
    v_mov_b32 v103, 0
    s_mov_b32 exec_lo, -1
    s_nop 0
    v_mfma_f32_16x16x32_bf16 v[104:107], v[96:99], v[64:67], 0
    v_mfma_f32_16x16x32_bf16 v[108:111], v[96:99], v[80:83], 0
    v_mfma_f32_16x16x32_bf16 v[104:107], v[96:99], v[68:71], v[104:107]
    v_mfma_f32_16x16x32_bf16 v[108:111], v[96:99], v[84:87], v[108:111]
    v_mfma_f32_16x16x32_bf16 v[104:107], v[96:99], v[72:75], v[104:107]
    v_mfma_f32_16x16x32_bf16 v[108:111], v[96:99], v[88:91], v[108:111]
    v_mfma_f32_16x16x32_bf16 v[104:107], v[96:99], v[76:79], v[104:107]
    v_mfma_f32_16x16x32_bf16 v[108:111], v[96:99], v[92:95], v[108:111]
    s_nop 6
    v_mul_f32 v104, 0xbb124925, v104
    v_mul_f32 v105, 0xbb124925, v108
    ds_write_b64 v40, v[104:105] offset:4096
    s_waitcnt lgkmcnt(0)
    s_mov_b32 s40, 131072
    s_branch L_ph_chk
L_ph:
    global_load_dwordx4 v[128:131], v9, s[26:27] offset:0 sc1
    global_load_dwordx4 v[132:135], v9, s[26:27] offset:1024 sc1
    global_load_dwordx4 v[136:139], v9, s[26:27] offset:2048 sc1
Lpad11:
    s_cbranch_execz L_back
    global_load_dwordx4 v[140:143], v10, s[26:27] offset:3072 sc1
    s_sub_u32 s40, s40, 1
    s_cbranch_scc1 L_ph_done
L_ph_chk:
    s_waitcnt vmcnt(0)
    v_max3_u32 v4, v128, v129, v130
    v_max3_u32 v4, v4, v131, v132
    v_max3_u32 v4, v4, v133, v134
    v_max3_u32 v4, v4, v135, v136
    v_max3_u32 v4, v4, v137, v138
    v_max3_u32 v4, v4, v139, v140
    v_max3_u32 v4, v4, v141, v142
    v_max_u32 v4, v4, v143
    v_cmp_eq_u32 vcc, -1, v4
    s_and_b64 exec, exec, vcc
    s_cbranch_scc1 L_ph
L_ph_done:
    s_mov_b64 exec, -1
    v_mfma_f32_16x16x32_bf16 v[112:115], v[128:131], v[96:99], 0
    v_mfma_f32_16x16x32_bf16 v[112:115], v[132:135], v[96:99], v[112:115]
    v_mfma_f32_16x16x32_bf16 v[112:115], v[136:139], v[96:99], v[112:115]
    v_mfma_f32_16x16x32_bf16 v[112:115], v[140:143], v[100:103], v[112:115]
    s_barrier
    ds_read_b128 v[32:35], v41 offset:4096
    ds_read_b128 v[36:39], v41 offset:4112
    v_mfma_f32_16x16x32_bf16 v[104:107], v[128:131], v[64:67], 0
    v_mfma_f32_16x16x32_bf16 v[104:107], v[132:135], v[68:71], v[104:107]
    v_mfma_f32_16x16x32_bf16 v[104:107], v[136:139], v[72:75], v[104:107]
    v_mfma_f32_16x16x32_bf16 v[104:107], v[140:143], v[76:79], v[104:107]
    v_mfma_f32_16x16x32_bf16 v[108:111], v[128:131], v[80:83], 0
    v_mfma_f32_16x16x32_bf16 v[108:111], v[132:135], v[84:87], v[108:111]
    v_mfma_f32_16x16x32_bf16 v[108:111], v[136:139], v[88:91], v[108:111]
    v_mfma_f32_16x16x32_bf16 v[108:111], v[140:143], v[92:95], v[108:111]
    v_pk_add_f32 v[112:113], v[112:113], v[114:115]
    s_waitcnt lgkmcnt(0)
    v_pk_add_f32 v[32:33], v[32:33], v[34:35]
    v_pk_add_f32 v[36:37], v[36:37], v[38:39]
    v_pk_add_f32 v[44:45], v[32:33], v[36:37]
    v_pk_add_f32 v[104:105], v[104:105], v[106:107]
    v_pk_fma_f32 v[104:105], v[112:113], v[44:45], v[104:105] op_sel_hi:[1,0,1]
    s_nop 0
    v_pk_add_f32 v[108:109], v[108:109], v[110:111]
    v_pk_fma_f32 v[108:109], v[112:113], v[44:45], v[108:109] op_sel:[0,1,0] op_sel_hi:[1,1,1]
    v_permlane32_swap_b32 v104, v105
    v_add_f32 v104, v104, v105
    v_permlane32_swap_b32 v108, v109
    v_add_f32 v108, v108, v109
    s_nop 1
    v_permlane16_swap_b32 v104, v108
    v_add_f32 v104, v104, v108
    ds_write_b32 v119, v104 offset:2048
    s_waitcnt lgkmcnt(0)
    s_barrier
    ds_read_b128 v[16:19], v117 offset:2048
    ds_read_b128 v[20:23], v117 offset:2112
    ds_read_b128 v[24:27], v117 offset:2304
    ds_read_b128 v[28:31], v117 offset:2368
    ds_read_b128 v[32:35], v117 offset:2560
    ds_read_b128 v[36:39], v117 offset:2624
    ds_read_b128 v[40:43], v117 offset:2816
    ds_read_b128 v[44:47], v117 offset:2880
    s_waitcnt lgkmcnt(4)
    v_pk_add_f32 v[16:17], v[16:17], v[24:25]
    v_pk_add_f32 v[18:19], v[18:19], v[26:27]
    v_pk_add_f32 v[20:21], v[20:21], v[28:29]
    v_pk_add_f32 v[22:23], v[22:23], v[30:31]
    s_waitcnt lgkmcnt(0)
    v_pk_add_f32 v[32:33], v[32:33], v[40:41]
    v_pk_add_f32 v[34:35], v[34:35], v[42:43]
    v_pk_add_f32 v[36:37], v[36:37], v[44:45]
    v_pk_add_f32 v[38:39], v[38:39], v[46:47]
    v_pk_add_f32 v[16:17], v[16:17], v[32:33]
    v_pk_add_f32 v[18:19], v[18:19], v[34:35]
    v_pk_add_f32 v[20:21], v[20:21], v[36:37]
    v_pk_add_f32 v[22:23], v[22:23], v[38:39]
    v_pk_mul_f32 v[16:17], v[16:17], v[20:21]
    v_pk_mul_f32 v[18:19], v[18:19], v[22:23]
    v_cvt_pk_bf16_f32 v16, v16, v16
    v_cvt_pk_bf16_f32 v17, v17, v17
    v_cvt_pk_bf16_f32 v18, v18, v18
    v_cvt_pk_bf16_f32 v19, v19, v19
    v_and_b32 v64, v16, v122
    v_and_b32 v65, v16, v123
    v_and_b32 v66, v16, v124
    v_and_b32 v67, v16, v125
    v_and_b32 v68, v17, v122
    v_and_b32 v69, v17, v123
    v_and_b32 v70, v17, v124
    v_and_b32 v71, v17, v125
    v_mfma_f32_16x16x32_bf16 v[104:107], v[64:67], v[48:51], 0
    v_and_b32 v72, v18, v122
    v_and_b32 v73, v18, v123
    v_and_b32 v74, v18, v124
    v_and_b32 v75, v18, v125
    v_mfma_f32_16x16x32_bf16 v[104:107], v[68:71], v[52:55], v[104:107]
    v_and_b32 v76, v19, v122
    v_and_b32 v77, v19, v123
    v_and_b32 v78, v19, v124
    v_and_b32 v79, v19, v125
    v_mfma_f32_16x16x32_bf16 v[104:107], v[72:75], v[56:59], v[104:107]
    s_nop 0
    v_mfma_f32_16x16x32_bf16 v[104:107], v[76:79], v[60:63], v[104:107]
    s_nop 7
    v_cvt_pk_bf16_f32 v104, v104, v105
    v_cvt_pk_bf16_f32 v105, v106, v107
    v_min_u32 v104, -2, v104
    v_min_u32 v105, -2, v105
    s_nop 0
    v_permlane16_swap_b32 v104, v106
    v_permlane16_swap_b32 v105, v107
    s_mov_b32 exec_lo, s43
    s_mov_b32 exec_hi, s43
    global_store_dwordx4 v116, v[104:107], s[26:27] sc1
    s_endpgm
L_oslowf:
    global_store_dword v14, v24, s[26:27] sc1
    s_lshl_b32 s38, s29, 7
    s_lshl_b32 s39, s30, 2
    s_add_u32 s39, s39, s38
    v_mov_b32 v4, s39
    v_mov_b32 v6, s33
    s_waitcnt vmcnt(0)
    s_barrier
    s_cmp_lg_u32 s28, 0
    s_cbranch_scc1 L_osl1f
    global_store_dword v4, v6, s[26:27] offset:3072 sc1
L_osl1f:
    s_branch L_opubf
L_kfinal:
    s_barrier
    s_waitcnt vmcnt(1)
    s_cmp_eq_u32 s49, 0
    s_waitcnt lgkmcnt(0)
    s_barrier
    ds_read_b64 v[24:25], v13 offset:24576
    ds_read_b64 v[26:27], v13 offset:26624
    ds_read_b64 v[28:29], v13 offset:28672
    ds_read_b64 v[30:31], v13 offset:30720
    s_waitcnt lgkmcnt(0)
    v_pk_mul_f32 v[24:25], v[24:25], v[16:17] op_sel_hi:[1,0]
    v_pk_mul_f32 v[28:29], v[28:29], v[20:21] op_sel_hi:[1,0]
    v_pk_fma_f32 v[24:25], v[26:27], v[18:19], v[24:25] op_sel_hi:[1,0,1]
    v_pk_fma_f32 v[28:29], v[30:31], v[22:23], v[28:29] op_sel_hi:[1,0,1]
    v_pk_add_f32 v[24:25], v[24:25], v[28:29]
    v_cvt_pk_bf16_f32 v24, v24, v25
    v_min_u32 v24, -2, v24
    s_cbranch_scc0 L_oslowz
    global_store_dword v14, v24, s[26:27]
L_opubz:
    s_cmp_eq_u32 s95, 3
    s_cbranch_scc1 L_end2
    v_and_b32 v4, 1, v2
    v_lshlrev_b32 v4, 4, v4
    v_mov_b32 v6, 0xffff
    v_lshlrev_b32 v6, v4, v6
    v_bfe_u32 v4, v2, 1, 2
    v_cmp_eq_u32 vcc, 0, v4
    s_nop 1
    v_cndmask_b32 v40, 0, v6, vcc
    v_cmp_eq_u32 vcc, 1, v4
    s_nop 1
    v_cndmask_b32 v41, 0, v6, vcc
    v_cmp_eq_u32 vcc, 2, v4
    s_nop 1
    v_cndmask_b32 v42, 0, v6, vcc
    v_cmp_eq_u32 vcc, 3, v4
    s_nop 1
    v_cndmask_b32 v43, 0, v6, vcc
    v_lshrrev_b32 v6, 3, v2
    v_cmp_eq_u32 vcc, v6, v7
    v_mov_b32 v6, 0x3f803f80
    v_and_b32 v44, v40, v6
    v_and_b32 v45, v41, v6
    v_and_b32 v46, v42, v6
    v_and_b32 v47, v43, v6
    v_cndmask_b32 v40, 0, v44, vcc
    v_cndmask_b32 v41, 0, v45, vcc
    v_cndmask_b32 v42, 0, v46, vcc
    v_cndmask_b32 v43, 0, v47, vcc
    v_lshrrev_b32 v9, 2, v2
Lpad12:
    s_cbranch_execz L_back
    v_lshlrev_b32 v9, 10, v9
    v_lshl_add_u32 v9, v3, 6, v9
    v_lshl_add_u32 v9, v5, 4, v9
    s_lshl_b32 s38, s28, 12
    s_add_u32 s38, s38, 720896
    v_add_u32 v9, s38, v9
    v_lshrrev_b32 v10, 1, v3
    v_mul_u32_u24 v10, 896, v10
    v_lshl_add_u32 v10, v2, 4, v10
    v_lshl_add_u32 v10, v7, 3, v10
    s_lshl_b32 s38, s28, 8
    v_add_u32 v10, s38, v10
    s_mov_b32 s40, 131072
    s_branch L_grz_chk
L_grz:
    s_sleep 2
    global_load_dword v121, v120, s[26:27] sc1
    s_sub_u32 s40, s40, 1
    s_cbranch_scc1 L_grz_done
L_grz_chk:
    s_waitcnt vmcnt(0)
    v_cmp_ne_u32 vcc, s33, v121
    s_cbranch_vccnz L_grz
L_grz_done:
    s_mov_b32 s40, 131072
    s_mov_b32 exec_lo, s46
    s_mov_b32 exec_hi, s46
L_ph2:
    global_load_dwordx4 v[16:19], v9, s[26:27] offset:0 sc1
    global_load_dwordx4 v[20:23], v9, s[26:27] offset:256 sc1
    global_load_dwordx4 v[24:27], v9, s[26:27] offset:512 sc1
    global_load_dwordx4 v[28:31], v9, s[26:27] offset:768 sc1
    s_sub_u32 s40, s40, 1
    s_cbranch_scc1 L_ph2_done
L_ph2_chk:
    s_waitcnt vmcnt(0)
    v_max3_u32 v4, v16, v17, v18
    v_max3_u32 v4, v4, v19, v20
    v_max3_u32 v4, v4, v21, v22
    v_max3_u32 v4, v4, v23, v24
    v_max3_u32 v4, v4, v25, v26
    v_max3_u32 v4, v4, v27, v28
    v_max3_u32 v4, v4, v29, v30
    v_max_u32 v4, v4, v31
    v_cmp_eq_u32 vcc, -1, v4
    s_and_b64 exec, exec, vcc
    s_cbranch_scc1 L_ph2
L_ph2_done:
    s_mov_b64 exec, -1
    v_mfma_f32_16x16x32_bf16 v[48:51], v[40:43], v[16:19], 0
    v_mfma_f32_16x16x32_bf16 v[48:51], v[40:43], v[20:23], v[48:51]
    v_mfma_f32_16x16x32_bf16 v[48:51], v[40:43], v[24:27], v[48:51]
    v_mfma_f32_16x16x32_bf16 v[48:51], v[40:43], v[28:31], v[48:51]
    s_mov_b32 exec_lo, s46
    s_mov_b32 exec_hi, s46
    s_nop 5
    v_cvt_pk_bf16_f32 v48, v48, v49
    v_cvt_pk_bf16_f32 v49, v50, v51
    ds_write_b64 v10, v[48:49] offset:0
    s_mov_b64 exec, -1
    s_waitcnt lgkmcnt(0)
    s_barrier
    s_cmp_lg_u32 s28, 0
    s_cbranch_scc1 L_epoch
    v_and_b32 v4, 31, v0
    v_cmp_gt_u32 s[36:37], 28, v4
    s_cmp_ge_u32 s44, 14
    s_cselect_b32 s38, 896, 0
    v_lshl_add_u32 v12, v4, 5, s38
    v_mov_b32 v16, 0
    v_mov_b32 v17, 0
    v_mov_b32 v18, 0
    v_mov_b32 v19, 0
    v_mov_b32 v20, 0
    v_mov_b32 v21, 0
    v_mov_b32 v22, 0
    v_mov_b32 v23, 0
    v_lshlrev_b32 v13, 4, v5
    v_lshl_add_u32 v13, v7, 3, v13
    s_lshl_b32 s38, s44, 6
    v_add_u32 v13, s38, v13
    ds_read_b64 v[60:61], v13 offset:0
    s_mov_b64 exec, s[36:37]
    ds_read_b128 v[16:19], v12 offset:0
    ds_read_b128 v[20:23], v12 offset:16
    s_mov_b64 exec, -1
    s_mul_i32 s38, s44, 7168
    s_add_u32 s38, s38, 741376
    v_lshl_add_u32 v9, v0, 4, s38
    s_waitcnt lgkmcnt(0)
    v_lshlrev_b32 v64, 16, v16
    v_and_b32 v65, s94, v16
    v_lshlrev_b32 v66, 16, v17
    v_and_b32 v67, s94, v17
    v_lshlrev_b32 v68, 16, v18
    v_and_b32 v69, s94, v18
    v_lshlrev_b32 v70, 16, v19
    v_and_b32 v71, s94, v19
    v_lshlrev_b32 v72, 16, v20
    v_and_b32 v73, s94, v20
    v_lshlrev_b32 v74, 16, v21
    v_and_b32 v75, s94, v21
    v_lshlrev_b32 v76, 16, v22
    v_and_b32 v77, s94, v22
    v_lshlrev_b32 v78, 16, v23
    v_and_b32 v79, s94, v23
    v_add_f32 v48, v64, v65
    v_add_f32 v48, v48, v66
    v_add_f32 v48, v48, v67
    v_add_f32 v48, v48, v68
    v_add_f32 v48, v48, v69
    v_add_f32 v48, v48, v70
    v_add_f32 v48, v48, v71
    v_add_f32 v48, v48, v72
    v_add_f32 v48, v48, v73
    v_add_f32 v48, v48, v74
    v_add_f32 v48, v48, v75
    v_add_f32 v48, v48, v76
    v_add_f32 v48, v48, v77
    v_add_f32 v48, v48, v78
    v_add_f32 v48, v48, v79
    s_nop 1
    v_add_f32_dpp v48, v48, v48 row_ror:8 row_mask:0xf bank_mask:0xf
    s_nop 1
    v_add_f32_dpp v48, v48, v48 row_ror:4 row_mask:0xf bank_mask:0xf
    s_nop 1
    v_add_f32_dpp v48, v48, v48 row_ror:2 row_mask:0xf bank_mask:0xf
    s_nop 1
    v_add_f32_dpp v48, v48, v48 row_ror:1 row_mask:0xf bank_mask:0xf
    v_mov_b32 v51, v48
    s_nop 1
    v_permlane16_swap_b32 v48, v51
    v_add_f32 v48, v48, v51
    v_mul_f32 v48, 0x3b124925, v48
    v_sub_f32 v51, v64, v48
    v_mul_f32 v50, v51, v51
    v_sub_f32 v51, v65, v48
    v_fmac_f32 v50, v51, v51
    v_sub_f32 v51, v66, v48
    v_fmac_f32 v50, v51, v51
    v_sub_f32 v51, v67, v48
    v_fmac_f32 v50, v51, v51
    v_sub_f32 v51, v68, v48
    v_fmac_f32 v50, v51, v51
    v_sub_f32 v51, v69, v48
    v_fmac_f32 v50, v51, v51
    v_sub_f32 v51, v70, v48
    v_fmac_f32 v50, v51, v51
    v_sub_f32 v51, v71, v48
    v_fmac_f32 v50, v51, v51
    v_sub_f32 v51, v72, v48
    v_fmac_f32 v50, v51, v51
    v_sub_f32 v51, v73, v48
    v_fmac_f32 v50, v51, v51
    v_sub_f32 v51, v74, v48
    v_fmac_f32 v50, v51, v51
    v_sub_f32 v51, v75, v48
    v_fmac_f32 v50, v51, v51
    v_sub_f32 v51, v76, v48
    v_fmac_f32 v50, v51, v51
    v_sub_f32 v51, v77, v48
    v_fmac_f32 v50, v51, v51
    v_sub_f32 v51, v78, v48
    v_fmac_f32 v50, v51, v51
    v_sub_f32 v51, v79, v48
    v_fmac_f32 v50, v51, v51
    v_cndmask_b32 v50, 0, v50, s[36:37]
    s_nop 1
    v_add_f32_dpp v50, v50, v50 row_ror:8 row_mask:0xf bank_mask:0xf
    s_nop 1
    v_add_f32_dpp v50, v50, v50 row_ror:4 row_mask:0xf bank_mask:0xf
    s_nop 1
    v_add_f32_dpp v50, v50, v50 row_ror:2 row_mask:0xf bank_mask:0xf
    s_nop 1
    v_add_f32_dpp v50, v50, v50 row_ror:1 row_mask:0xf bank_mask:0xf
    v_mov_b32 v51, v50
    s_nop 1
    v_permlane16_swap_b32 v50, v51
    v_add_f32 v50, v50, v51
    v_mul_f32 v50, 0x3b124925, v50
    v_cvt_pk_bf16_f32 v50, v50, v50
    v_and_b32 v50, s94, v50
    v_add_f32 v50, 0x3727c5ac, v50
    v_cvt_pk_bf16_f32 v50, v50, v50
    v_and_b32 v50, s94, v50
    v_sqrt_f32 v50, v50
    v_cvt_pk_bf16_f32 v48, v48, v48
    v_and_b32 v48, s94, v48
    v_cvt_pk_bf16_f32 v50, v50, v50
    v_and_b32 v50, s94, v50
    v_rcp_f32 v50, v50
    v_and_b32 v63, s94, v61
    v_lshlrev_b32 v62, 16, v61
    v_and_b32 v61, s94, v60
    v_lshlrev_b32 v60, 16, v60
    v_mul_f32 v50, v50, v50
    s_sleep 13
    s_mov_b32 s40, 131072
L_pp:
    global_load_dwordx4 v[64:67], v9, s[26:27] offset:-4096 sc1
    global_load_dwordx4 v[68:71], v9, s[26:27] offset:-3072 sc1
    global_load_dwordx4 v[72:75], v9, s[26:27] offset:-2048 sc1
    global_load_dwordx4 v[76:79], v9, s[26:27] offset:-1024 sc1
    global_load_dwordx4 v[80:83], v9, s[26:27] offset:0 sc1
Lpad13:
    s_cbranch_execz L_back
    global_load_dwordx4 v[84:87], v9, s[26:27] offset:1024 sc1
    global_load_dwordx4 v[88:91], v9, s[26:27] offset:2048 sc1
    s_sub_u32 s40, s40, 1
    s_cbranch_scc1 L_pp_done
L_pp_chk:
    s_waitcnt vmcnt(0)
    v_max3_u32 v4, v64, v65, v66
    v_max3_u32 v4, v4, v67, v68
    v_max3_u32 v4, v4, v69, v70
    v_max3_u32 v4, v4, v71, v72
    v_max3_u32 v4, v4, v73, v74
    v_max3_u32 v4, v4, v75, v76
    v_max3_u32 v4, v4, v77, v78
    v_max3_u32 v4, v4, v79, v80
    v_max3_u32 v4, v4, v81, v82
    v_max3_u32 v4, v4, v83, v84
    v_max3_u32 v4, v4, v85, v86
    v_max3_u32 v4, v4, v87, v88
    v_max3_u32 v4, v4, v89, v90
    v_max_u32 v4, v4, v91
    v_cmp_eq_u32 vcc, -1, v4
    s_and_b64 exec, exec, vcc
    s_cbranch_scc1 L_pp
L_pp_done:
    s_mov_b64 exec, -1
    v_mfma_f32_16x16x32_bf16 v[16:19], v[44:47], v[64:67], 0
    v_mfma_f32_16x16x32_bf16 v[16:19], v[44:47], v[68:71], v[16:19]
    v_mfma_f32_16x16x32_bf16 v[16:19], v[44:47], v[72:75], v[16:19]
    v_mfma_f32_16x16x32_bf16 v[16:19], v[44:47], v[76:79], v[16:19]
    v_mfma_f32_16x16x32_bf16 v[16:19], v[44:47], v[80:83], v[16:19]
    v_mfma_f32_16x16x32_bf16 v[16:19], v[44:47], v[84:87], v[16:19]
    v_mfma_f32_16x16x32_bf16 v[16:19], v[44:47], v[88:91], v[16:19]
    s_nop 7
    v_add_f32_dpp v16, v16, v16 row_ror:4 row_mask:0xf bank_mask:0xf
    v_add_f32_dpp v17, v17, v17 row_ror:4 row_mask:0xf bank_mask:0xf
    v_add_f32_dpp v18, v18, v18 row_ror:4 row_mask:0xf bank_mask:0xf
    v_add_f32_dpp v19, v19, v19 row_ror:4 row_mask:0xf bank_mask:0xf
    v_add_f32_dpp v16, v16, v16 row_ror:8 row_mask:0xf bank_mask:0xf
    v_add_f32_dpp v17, v17, v17 row_ror:8 row_mask:0xf bank_mask:0xf
    v_add_f32_dpp v18, v18, v18 row_ror:8 row_mask:0xf bank_mask:0xf
    v_add_f32_dpp v19, v19, v19 row_ror:8 row_mask:0xf bank_mask:0xf
    s_mov_b64 exec, 0x000f000f
    v_pk_mul_f32 v[16:17], v[16:17], v[50:51] op_sel_hi:[1,0]
    v_pk_mul_f32 v[18:19], v[18:19], v[50:51] op_sel_hi:[1,0]
    v_cvt_pk_bf16_f32 v16, v16, v17
    v_cvt_pk_bf16_f32 v18, v18, v19
    v_and_b32 v17, s94, v16
    v_lshlrev_b32 v16, 16, v16
    v_and_b32 v19, s94, v18
    v_lshlrev_b32 v18, 16, v18
    v_pk_add_f32 v[16:17], v[16:17], v[60:61]
    v_pk_add_f32 v[18:19], v[18:19], v[62:63]
    v_cvt_pk_bf16_f32 v16, v16, v17
    v_cvt_pk_bf16_f32 v17, v18, v19
    global_store_dwordx2 v13, v[16:17], s[22:23]
    s_endpgm
L_epoch:
    s_lshl_b32 s38, s44, 2
    s_add_u32 s38, s38, s28
    s_cmp_lg_u32 s38, 1
    s_cbranch_scc1 L_end2
    v_mov_b32 v15, 0
    v_mov_b32 v14, s33
    s_mov_b64 exec, 1
    global_store_dword v15, v14, s[26:27] offset:0 sc1
    s_branch L_end2
L_oslowz:
    global_store_dword v14, v24, s[26:27] sc1
    s_lshl_b32 s38, s29, 7
    s_lshl_b32 s39, s30, 2
    s_add_u32 s39, s39, s38
    v_mov_b32 v4, s39
    v_mov_b32 v6, s33
    s_waitcnt vmcnt(0)
    s_barrier
    s_cmp_lg_u32 s28, 0
    s_cbranch_scc1 L_osl1z
    global_store_dword v4, v6, s[26:27] offset:3072 sc1
L_osl1z:
    s_branch L_opubz
.section .rodata,"a"
.p2align 6
.amdhsa_kernel sequential_preLN__sliding_block_cached__glu_gated_bilinear__decode_kernel
  .amdhsa_next_free_vgpr 256
  .amdhsa_next_free_sgpr 96
  .amdhsa_accum_offset 256
  .amdhsa_group_segment_fixed_size 0
  .amdhsa_kernarg_size 96
  .amdhsa_user_sgpr_count 2
  .amdhsa_user_sgpr_kernarg_segment_ptr 1
  .amdhsa_system_sgpr_workgroup_id_x 1
  .amdhsa_float_denorm_mode_32 3
.end_amdhsa_kernel
```
